```python
import torch

def _softmax(x, axis=-1):
    return torch.softmax(x, dim=axis)
def _gelu(x):
    return torch.nn.functional.gelu(x, approximate="tanh")
def _silu(x):
    return torch.nn.functional.silu(x)
def _sigmoid(x):
    return torch.sigmoid(x)
def _layernorm(x, axis=-1, eps=1e-5):
    m = x.mean(dim=axis, keepdim=True)
    v = x.var(dim=axis, keepdim=True, unbiased=False)
    return (x - m) / torch.sqrt(v + eps)
def _scatter_add(tgt, idx, src, axis=0):
    return tgt.clone().index_add_(axis, idx, src)
def _segment_sum(src, seg, n):
    out = torch.zeros((n,) + src.shape[1:], dtype=src.dtype)
    return out.index_add_(0, seg, src)
def _pad(x, pw):
    flat = tuple(v for pair in reversed(pw) for v in pair)
    return torch.nn.functional.pad(x, flat)

kernel_name = 'gated_mix__linear_kernel_hedgehog__mixer_token_mlp__prompt'

def setup_inputs():

    _w = (lambda a: (lambda t: t.to(torch.bfloat16) if t.is_floating_point() else t)(torch.as_tensor(a)))
    def _A_setup():
        B, S, D, H = 1, 2048, 512, 32
        Dh = D // H
        return {
            "x": _w((lambda *s: torch.randn(*s, dtype=torch.bfloat16) * 0.05)(B, S, D)),
            "wqkv": _w((lambda *s: torch.randn(*s, dtype=torch.bfloat16) * 0.8)(D, 3 * D)),
            "w_phi": _w((lambda *s: torch.randn(*s, dtype=torch.bfloat16) * 0.8)(H, Dh, Dh) * (Dh ** -0.5)),
            "wo": _w((lambda *s: torch.randn(*s, dtype=torch.bfloat16) * 0.05)(D, D)),
        }
    _A_in = _A_setup()

    def _B_setup():
        B, S, D, F = 1, 2048, 512, 1792
        return {
            "x": _w((lambda *s: torch.randn(*s, dtype=torch.bfloat16) * 0.05)(B, S, D)),
            "w1": _w((lambda *s: torch.randn(*s, dtype=torch.bfloat16) * 0.4)(S, F) * (S ** -0.5)),
            "b1": _w((lambda *s: torch.randn(*s, dtype=torch.bfloat16) * 3.2)(F) * 0.02),
            "w2": _w((lambda *s: torch.randn(*s, dtype=torch.bfloat16) * 0.1)(F, S) * (F ** -0.5)),
            "b2": _w((lambda *s: torch.randn(*s, dtype=torch.bfloat16) * 0.4)(S) * 0.02),
        }
    _B_in = _B_setup()

    return {
        "A_x": _A_in["x"],
        "A_wqkv": _A_in["wqkv"],
        "A_w_phi": _A_in["w_phi"],
        "A_wo": _A_in["wo"],
        "B_x": _B_in["x"],
        "B_w1": _B_in["w1"],
        "B_b1": _B_in["b1"],
        "B_w2": _B_in["w2"],
        "B_b2": _B_in["b2"],
        "gate_w": _w((lambda *s: torch.randn(*s, dtype=torch.bfloat16) * 0.05)(512) * 16.0),
    }

def reference(A_x, A_wqkv, A_w_phi, A_wo, B_x, B_w1, B_b1, B_w2, B_b2, gate_w):
    def _A_ref(x, wqkv, w_phi, wo):
        B, S, D = x.shape
        H = 32; Dh = D // H
        qkv = (lambda x, *d: x.permute(*d))((x @ wqkv).reshape(B, S, 3, H, Dh), 2, 0, 3, 1, 4)
        q, k, v = qkv[0], qkv[1], qkv[2]
        pq = torch.einsum("bhsd,hdf->bhsf", q, w_phi)
        pk = torch.einsum("bhsd,hdf->bhsf", k, w_phi)
        phi_q = torch.concatenate([_softmax(pq, axis=-1), _softmax(-pq, axis=-1)], axis=-1)
        phi_k = torch.concatenate([_softmax(pk, axis=-1), _softmax(-pk, axis=-1)], axis=-1)
        kv = torch.einsum("bhsf,bhsd->bhfd", phi_k, v)
        z  = torch.einsum("bhsf->bhf", phi_k)
        num = torch.einsum("bhqf,bhfd->bhqd", phi_q, kv)
        den = torch.einsum("bhqf,bhf->bhq", phi_q, z)[..., None] + 1e-6
        o = num / den
        return (lambda x, *d: x.permute(*d))(o, 0, 2, 1, 3).reshape(B, S, D) @ wo

    def _B_ref(x, w1, b1, w2, b2):
        B, S, D = x.shape
        h = _layernorm(x, axis=-1)
        u = torch.einsum("bsd,sf->bdf", h, w1) + b1
        u = _gelu(u)
        y = torch.einsum("bdf,fs->bds", u, w2) + b2
        return (lambda x, *d: x.permute(*d))(y, 0, 2, 1)

    x = A_x
    g = _sigmoid((x * gate_w).sum(-1, keepdims=True))
    a = _A_ref(x, A_wqkv, A_w_phi, A_wo)
    b = _B_ref(x, B_w1, B_b1, B_w2, B_b2)
    return g * a + (1 - g) * b
```

```asm
; @launch grid=(256,1,1) block=(256,1,1) lds=163840
.amdgcn_target "amdgcn-amd-amdhsa--gfx950"
.text
.globl gated_mix__linear_kernel_hedgehog__mixer_token_mlp__prompt_kernel
.p2align 8
.type gated_mix__linear_kernel_hedgehog__mixer_token_mlp__prompt_kernel,@function
gated_mix__linear_kernel_hedgehog__mixer_token_mlp__prompt_kernel:
    s_load_dwordx16 s[16:31], s[0:1], 0
    s_load_dwordx8 s[32:39], s[0:1], 64
    s_load_dwordx2 s[40:41], s[0:1], 96
    s_cmp_ge_u32 s2, 256
    s_cbranch_scc1 L_end
    s_lshr_b32 s97, s2, 3
    s_cmp_lt_u32 s97, 24
    s_cbranch_scc1 L_nocpf
    s_getpc_b64 s[48:49]
L_pc:
    s_sub_u32 s48, s48, L_pc-gated_mix__linear_kernel_hedgehog__mixer_token_mlp__prompt_kernel
    s_subb_u32 s49, s49, 0
    s_mov_b32 s50, L_codeend-gated_mix__linear_kernel_hedgehog__mixer_token_mlp__prompt_kernel
    s_mov_b32 s51, 0x20000
    s_and_b32 s5, s97, 7
    s_lshl_b32 s5, s5, 13
    v_lshlrev_b32 v3, 5, v0
    buffer_load_dword v41, v3, s[48:51], s5 offen
L_nocpf:
    v_and_b32 v1, 63, v0
    v_lshrrev_b32 v2, 6, v0
    s_nop 0
    v_readfirstlane_b32 s3, v2
    s_and_b32 s96, s2, 7
    v_lshlrev_b32 v6, 4, v1
    v_lshlrev_b32 v7, 7, v1
    v_lshlrev_b32 v42, 2, v1
    v_lshrrev_b32 v2, 3, v1
    v_and_b32 v3, 7, v1
    v_lshrrev_b32 v4, 4, v1
    v_xor_b32 v5, v3, v4
    v_lshlrev_b32 v5, 4, v5
    v_lshl_add_u32 v43, v2, 10, v5
    v_xor_b32 v44, 64, v43
    v_add_u32 v44, 7168, v44
    v_and_b32 v4, 1, v4
    v_lshlrev_b32 v4, 2, v4
    v_xor_b32 v4, v3, v4
    v_lshlrev_b32 v10, 4, v4
    v_mul_u32_u24 v45, 3072, v2
    v_add_u32 v45, v45, v10
    v_add_u32 v46, 23552, v45
    s_lshr_b32 s11, s96, 1
    s_lshl_b32 s11, s11, 2
    s_and_b32 s5, s97, 3
    s_add_u32 s11, s11, s5
    s_and_b32 s6, s96, 1
    s_lshr_b32 s7, s97, 2
    s_lshl_b32 s12, s6, 2
    s_add_u32 s12, s12, s7
    s_lshl_b32 s15, s12, 7
    s_add_u32 s42, s15, 2048
    s_add_u32 s15, s15, 1024
    s_lshl_b32 s8, s6, 1
    s_add_u32 s8, s8, s7
    s_sub_u32 s8, s8, 4
    s_lshl_b32 s5, s8, 8
    s_add_u32 s6, s5, 128
    s_cmp_ge_u32 s97, 16
    s_cselect_b32 s12, s8, s12
    s_cselect_b32 s15, s5, s15
    s_cselect_b32 s42, s6, s42
    s_mul_i32 s5, s3, 49152
    s_add_u32 s15, s15, s5
    s_add_u32 s42, s42, s5
    s_lshl_b32 s14, s11, 17
    s_lshl_b32 s5, s3, 14
    s_add_u32 s14, s14, s5
    s_lshl_b32 s43, s3, 11
    s_lshl_b32 s13, s11, 1
    s_add_u32 s13, s13, s7
    s_add_u32 s13, s13, s96
    s_and_b32 s13, s13, 7
    s_and_b32 s9, s3, 1
    s_lshr_b32 s10, s3, 1
    s_cmp_ge_u32 s97, 24
    s_waitcnt lgkmcnt(0)
    s_mov_b32 s44, s16
    s_mov_b32 s45, s17
    s_mov_b32 s46, 0x200000
    s_mov_b32 s47, 0x20000
    s_cbranch_scc1 L_helper
    s_mov_b32 s48, s18
    s_mov_b32 s49, s19
    s_mov_b32 s50, 0x180000
    s_mov_b32 s51, 0x20000
    s_lshl_b32 s90, s13, 7
    s_add_u32 s90, s90, s14
    s_add_u32 m0, s43, 0
    s_mul_i32 s91, s13, 196608
    buffer_load_dwordx4 v43, s[44:47], s90 offen lds
    buffer_load_dwordx4 v44, s[44:47], s90 offen offset:1024 lds
    s_add_u32 s90, s90, 65536
    s_add_u32 m0, s43, 40960
    s_mul_i32 s91, s13, 196608
    buffer_load_dwordx4 v43, s[44:47], s90 offen lds
    buffer_load_dwordx4 v44, s[44:47], s90 offen offset:1024 lds
    s_add_u32 m0, s43, 81920
    s_add_u32 s90, s91, s15
    buffer_load_dwordx4 v45, s[48:51], s90 offen lds
    buffer_load_dwordx4 v46, s[48:51], s90 offen offset:1024 lds
    s_add_u32 m0, s43, 122880
    s_add_u32 s90, s91, s42
    buffer_load_dwordx4 v45, s[48:51], s90 offen lds
    buffer_load_dwordx4 v46, s[48:51], s90 offen offset:1024 lds
    s_add_u32 s13, s13, 1
    s_and_b32 s13, s13, 7
    s_mov_b32 s84, s40
    s_mov_b32 s85, s41
    s_mov_b32 s86, 0xe00000
    s_mov_b32 s87, 0x20000
    s_mov_b32 s52, s20
    s_mov_b32 s53, s21
    s_mov_b32 s54, 0x4000
    s_mov_b32 s55, 0x20000
    s_mov_b32 s60, s26
    s_mov_b32 s61, s27
    s_mov_b32 s62, 0x700000
    s_mov_b32 s63, 0x20000
    s_mov_b32 s64, s28
    s_mov_b32 s65, s29
    s_mov_b32 s66, 0xe00
    s_mov_b32 s67, 0x20000
    s_mov_b32 s68, s30
    s_mov_b32 s69, s31
    s_mov_b32 s70, 0x700000
    s_mov_b32 s71, 0x20000
    s_mov_b32 s72, s32
    s_mov_b32 s73, s33
    s_mov_b32 s74, 0x1000
    s_mov_b32 s75, 0x20000
    s_mov_b32 s76, s22
    s_mov_b32 s77, s23
    s_mov_b32 s78, 0x80000
    s_mov_b32 s79, 0x20000
    s_mov_b32 s80, s36
    s_mov_b32 s81, s37
    s_mov_b32 s82, 0x200000
    s_mov_b32 s83, 0x20000
    s_mov_b32 s94, 0x3fb8aa3b
    s_mov_b32 s95, 0x3fb8aa3b
    s_mul_i32 s20, s3, 40960
    s_and_b32 s21, s96, 1
    s_lshl_b32 s21, s21, 2
    s_and_b32 s5, s97, 3
    s_add_u32 s21, s21, s5
    s_lshr_b32 s22, s96, 1
    s_mul_i32 s22, s22, 7
    s_lshr_b32 s6, s97, 2
    s_add_u32 s22, s22, s6
    s_lshl_b32 s23, s21, 2
    s_lshl_b32 s24, s21, 13
    s_lshl_b32 s25, s21, 18
    s_lshl_b32 s7, s3, 16
    s_add_u32 s25, s25, s7
    s_mul_i32 s26, s3, 1835008
    s_lshl_b32 s7, s22, 7
    s_add_u32 s26, s26, s7
    s_lshl_b32 s27, s96, 2
    s_add_u32 s27, s27, s97
    s_sub_u32 s27, s27, 28
    s_and_b32 s28, s97, 7
    s_lshl_b32 s29, s96, 2
    s_lshr_b32 s7, s97, 3
    s_add_u32 s29, s29, s7
    s_mul_i32 s32, s28, 112
    s_mul_i32 s7, s3, 28
    s_add_u32 s32, s32, s7
    s_lshl_b32 s32, s32, 11
    s_add_u32 s32, s32, 0x400000
    s_lshl_b32 s33, s7, 16
    s_lshl_b32 s7, s29, 7
    s_add_u32 s33, s33, s7
    s_lshl_b32 s34, s29, 16
    s_lshl_b32 s7, s3, 14
    s_add_u32 s34, s34, s7
    s_add_u32 s34, s34, 0x600000
    s_lshl_b32 s35, s3, 17
    s_lshl_b32 s7, s28, 7
    s_add_u32 s35, s35, s7
    v_lshrrev_b32 v4, 3, v1
    v_mul_u32_u24 v11, 3584, v4
    v_add_u32 v11, v11, v10
    v_add_u32 v12, 27648, v11
    v_mul_u32_u24 v19, 4096, v4
    v_add_u32 v19, v19, v10
    v_add_u32 v20, 31744, v19
    v_mul_u32_u24 v21, 1024, v4
    v_add_u32 v21, v21, v10
    v_add_u32 v22, 7168, v21
    s_lshl_b32 s5, s9, 6
    s_lshl_b32 s6, s10, 6
    v_bfe_u32 v2, v1, 2, 2
    v_lshrrev_b32 v3, 5, v1
    v_lshl_add_u32 v2, v3, 3, v2
    v_lshlrev_b32 v2, 7, v2
    v_bfe_u32 v3, v1, 4, 1
    v_lshl_add_u32 v2, v3, 5, v2
    v_and_b32 v3, 3, v1
    v_lshl_add_u32 v2, v3, 3, v2
    v_bfe_u32 v3, v1, 3, 1
    v_lshl_add_u32 v13, v3, 6, v2
    v_xor_b32 v13, s6, v13
    v_add_u32 v13, s20, v13
    v_xor_b32 v14, 64, v13
    v_bfe_u32 v2, v1, 2, 2
    v_lshrrev_b32 v3, 5, v1
    v_lshl_add_u32 v2, v3, 2, v2
    v_lshlrev_b32 v2, 7, v2
    v_bfe_u32 v3, v1, 4, 1
    v_lshl_add_u32 v2, v3, 5, v2
    v_and_b32 v3, 3, v1
    v_lshl_add_u32 v2, v3, 3, v2
    v_bfe_u32 v3, v1, 3, 1
    v_lshl_add_u32 v23, v3, 6, v2
    v_add_u32 v23, s20, v23
    v_xor_b32 v25, s6, v23
    v_xor_b32 v23, s5, v23
    v_xor_b32 v24, 64, v23
    v_xor_b32 v26, 64, v25
    s_lshl_b32 s5, s9, 10
    s_lshl_b32 s6, s10, 10
    v_add_u32 v15, s5, v6
    v_add_u32 v17, s6, v6
    v_xor_b32 v16, 0x400, v15
    v_xor_b32 v18, 0x400, v17
    v_add_u32 v27, s20, v6
    v_and_b32 v3, 16, v1
    v_cmp_ne_u32 s[98:99], 0, v3
    v_and_b32 v2, 31, v1
    v_bfe_u32 v3, v1, 1, 3
    v_lshrrev_b32 v4, 5, v1
    v_xor_b32 v3, v3, v4
    v_lshlrev_b32 v3, 4, v3
    v_lshl_add_u32 v3, v2, 7, v3
    s_mul_i32 s5, s9, 40960
    v_add_u32 v47, s5, v3
    v_xor_b32 v48, 32, v47
    v_xor_b32 v49, 64, v47
    v_xor_b32 v50, 96, v47
    v_subrev_u32 v51, s20, v13
    v_add_u32 v52, 122880, v51
    v_add_u32 v51, 81920, v51
    v_bfe_u32 v2, v1, 2, 2
    v_lshrrev_b32 v3, 5, v1
    v_lshl_add_u32 v2, v3, 2, v2
    v_bfe_u32 v4, v1, 4, 1
    v_and_b32 v5, 3, v1
    v_lshlrev_b32 v5, 3, v5
    v_lshl_add_u32 v41, v2, 5, v5
    v_lshl_add_u32 v41, v4, 9, v41
    v_add_u32 v41, s20, v41
    s_lshl_b32 s38, s3, 11
    s_add_u32 s38, s38, 0xc10000
    v_and_b32 v9, 1920, v7
    s_lshl_b32 s90, s13, 7
    s_add_u32 s90, s90, s14
    s_add_u32 m0, s43, 8192
    s_mul_i32 s91, s13, 196608
    buffer_load_dwordx4 v43, s[44:47], s90 offen lds
    buffer_load_dwordx4 v44, s[44:47], s90 offen offset:1024 lds
    s_add_u32 s90, s90, 65536
    s_add_u32 m0, s43, 49152
    s_mul_i32 s91, s13, 196608
    buffer_load_dwordx4 v43, s[44:47], s90 offen lds
    buffer_load_dwordx4 v44, s[44:47], s90 offen offset:1024 lds
    s_add_u32 m0, s43, 90112
    s_add_u32 s90, s91, s15
    buffer_load_dwordx4 v45, s[48:51], s90 offen lds
    buffer_load_dwordx4 v46, s[48:51], s90 offen offset:1024 lds
    s_add_u32 m0, s43, 131072
    s_add_u32 s90, s91, s42
    buffer_load_dwordx4 v45, s[48:51], s90 offen lds
    buffer_load_dwordx4 v46, s[48:51], s90 offen offset:1024 lds
    s_add_u32 s13, s13, 1
    s_and_b32 s13, s13, 7
    s_waitcnt vmcnt(8)
    s_barrier
    ds_read_b128 v[128:131], v47 offset:0
    ds_read_b64_tr_b16 v[136:137], v51 offset:0
    ds_read_b64_tr_b16 v[138:139], v51 offset:512
    ds_read_b128 v[132:135], v47 offset:4096
    ds_read_b64_tr_b16 v[140:141], v52 offset:0
    ds_read_b64_tr_b16 v[142:143], v52 offset:512
    s_lshl_b32 s90, s13, 7
    s_add_u32 s90, s90, s14
    s_add_u32 m0, s43, 16384
    s_mul_i32 s91, s13, 196608
    buffer_load_dwordx4 v43, s[44:47], s90 offen lds
    buffer_load_dwordx4 v44, s[44:47], s90 offen offset:1024 lds
    s_add_u32 s90, s90, 65536
    s_add_u32 m0, s43, 57344
    s_mul_i32 s91, s13, 196608
    buffer_load_dwordx4 v43, s[44:47], s90 offen lds
    buffer_load_dwordx4 v44, s[44:47], s90 offen offset:1024 lds
    ds_read_b128 v[144:147], v48 offset:0
    ds_read_b64_tr_b16 v[152:153], v51 offset:2048
    ds_read_b64_tr_b16 v[154:155], v51 offset:2560
    ds_read_b128 v[148:151], v48 offset:4096
    ds_read_b64_tr_b16 v[156:157], v52 offset:2048
    ds_read_b64_tr_b16 v[158:159], v52 offset:2560
    s_waitcnt lgkmcnt(6)
    v_mfma_f32_32x32x16_bf16 v[64:79], v[136:139], v[128:131], 0
    ds_read_b128 v[160:163], v49 offset:0
    ds_read_b64_tr_b16 v[168:169], v51 offset:4096
    ds_read_b64_tr_b16 v[170:171], v51 offset:4608
    ds_read_b128 v[164:167], v49 offset:4096
    ds_read_b64_tr_b16 v[172:173], v52 offset:4096
    v_mfma_f32_32x32x16_bf16 v[80:95], v[136:139], v[132:135], 0
    ds_read_b64_tr_b16 v[174:175], v52 offset:4608
    s_add_u32 m0, s43, 98304
    s_add_u32 s90, s91, s15
    buffer_load_dwordx4 v45, s[48:51], s90 offen lds
    v_mfma_f32_32x32x16_bf16 v[96:111], v[140:143], v[128:131], 0
    buffer_load_dwordx4 v46, s[48:51], s90 offen offset:1024 lds
    s_add_u32 m0, s43, 139264
    s_add_u32 s90, s91, s42
    v_mfma_f32_32x32x16_bf16 v[112:127], v[140:143], v[132:135], 0
    buffer_load_dwordx4 v45, s[48:51], s90 offen lds
    buffer_load_dwordx4 v46, s[48:51], s90 offen offset:1024 lds
    s_add_u32 s13, s13, 1
    s_and_b32 s13, s13, 7
    s_waitcnt lgkmcnt(6)
    v_mfma_f32_32x32x16_bf16 v[64:79], v[152:155], v[144:147], v[64:79]
    ds_read_b128 v[128:131], v50 offset:0
    ds_read_b64_tr_b16 v[136:137], v51 offset:6144
    ds_read_b64_tr_b16 v[138:139], v51 offset:6656
    ds_read_b128 v[132:135], v50 offset:4096
    ds_read_b64_tr_b16 v[140:141], v52 offset:6144
    v_mfma_f32_32x32x16_bf16 v[80:95], v[152:155], v[148:151], v[80:95]
    ds_read_b64_tr_b16 v[142:143], v52 offset:6656
    s_lshl_b32 s90, s13, 7
    s_add_u32 s90, s90, s14
    s_add_u32 m0, s43, 24576
    s_mul_i32 s91, s13, 196608
    v_mfma_f32_32x32x16_bf16 v[96:111], v[156:159], v[144:147], v[96:111]
    buffer_load_dwordx4 v43, s[44:47], s90 offen lds
    buffer_load_dwordx4 v44, s[44:47], s90 offen offset:1024 lds
    s_add_u32 s90, s90, 65536
    s_add_u32 m0, s43, 65536
    v_mfma_f32_32x32x16_bf16 v[112:127], v[156:159], v[148:151], v[112:127]
    s_mul_i32 s91, s13, 196608
    buffer_load_dwordx4 v43, s[44:47], s90 offen lds
    buffer_load_dwordx4 v44, s[44:47], s90 offen offset:1024 lds
    s_waitcnt vmcnt(12) lgkmcnt(0)
    s_barrier
    v_mfma_f32_32x32x16_bf16 v[64:79], v[168:171], v[160:163], v[64:79]
    ds_read_b128 v[144:147], v47 offset:8192
    ds_read_b64_tr_b16 v[152:153], v51 offset:8192
    ds_read_b64_tr_b16 v[154:155], v51 offset:8704
    ds_read_b128 v[148:151], v47 offset:12288
    ds_read_b64_tr_b16 v[156:157], v52 offset:8192
    v_mfma_f32_32x32x16_bf16 v[80:95], v[168:171], v[164:167], v[80:95]
    ds_read_b64_tr_b16 v[158:159], v52 offset:8704
    s_add_u32 m0, s43, 106496
    s_add_u32 s90, s91, s15
    buffer_load_dwordx4 v45, s[48:51], s90 offen lds
    v_mfma_f32_32x32x16_bf16 v[96:111], v[172:175], v[160:163], v[96:111]
    buffer_load_dwordx4 v46, s[48:51], s90 offen offset:1024 lds
    s_add_u32 m0, s43, 147456
    s_add_u32 s90, s91, s42
    v_mfma_f32_32x32x16_bf16 v[112:127], v[172:175], v[164:167], v[112:127]
    buffer_load_dwordx4 v45, s[48:51], s90 offen lds
    buffer_load_dwordx4 v46, s[48:51], s90 offen offset:1024 lds
    s_add_u32 s13, s13, 1
    s_and_b32 s13, s13, 7
    v_mfma_f32_32x32x16_bf16 v[64:79], v[136:139], v[128:131], v[64:79]
    ds_read_b128 v[160:163], v48 offset:8192
    ds_read_b64_tr_b16 v[168:169], v51 offset:10240
    ds_read_b64_tr_b16 v[170:171], v51 offset:10752
    ds_read_b128 v[164:167], v48 offset:12288
    ds_read_b64_tr_b16 v[172:173], v52 offset:10240
    ds_read_b64_tr_b16 v[174:175], v52 offset:10752
    s_mov_b32 s5, 0xc38000
    v_mov_b32 v2, 0
    buffer_load_dword v8, v2, s[84:87], s5 offen sc1
    s_lshl_b32 s5, s12, 11
    s_lshl_b32 s7, s12, 12
    s_cmp_ge_u32 s97, 16
    v_mfma_f32_32x32x16_bf16 v[80:95], v[136:139], v[132:135], v[80:95]
    s_cselect_b32 s5, s7, s5
    s_lshl_b32 s6, s10, 10
    s_add_u32 s5, s5, s6
    s_add_u32 m0, s20, 38912
    s_add_u32 s6, s5, 2048
    buffer_load_dwordx4 v6, s[52:55], s5 offen lds
    s_add_u32 m0, s20, 39936
    s_nop 0
    buffer_load_dwordx4 v6, s[52:55], s6 offen lds
    s_mul_i32 s92, s28, 7
    s_lshr_b32 s92, s92, 1
    s_and_b32 s93, s29, 7
    s_lshl_b32 s5, s10, 6
    s_lshl_b32 s6, s22, 7
    v_mfma_f32_32x32x16_bf16 v[96:111], v[140:143], v[128:131], v[96:111]
    s_add_u32 s5, s5, s6
    v_lshrrev_b32 v2, 5, v1
    v_lshlrev_b32 v2, 3, v2
    buffer_load_dwordx2 v[28:29], v2, s[64:67], s5 offen offset:0
    buffer_load_dwordx2 v[30:31], v2, s[64:67], s5 offen offset:16
    buffer_load_dwordx2 v[32:33], v2, s[64:67], s5 offen offset:32
    buffer_load_dwordx2 v[34:35], v2, s[64:67], s5 offen offset:48
    v_and_b32 v2, 31, v1
    v_mfma_f32_32x32x16_bf16 v[112:127], v[140:143], v[132:135], v[112:127]
    v_lshlrev_b32 v3, 1, v2
    s_lshl_b32 s5, s29, 7
    s_lshl_b32 s6, s9, 6
    s_add_u32 s5, s5, s6
    buffer_load_ushort v40, v3, s[72:75], s5 offen
    s_lshl_b32 s90, s13, 7
    s_add_u32 s90, s90, s14
    s_add_u32 m0, s43, 0
    s_mul_i32 s91, s13, 196608
    buffer_load_dwordx4 v43, s[44:47], s90 offen lds
    buffer_load_dwordx4 v44, s[44:47], s90 offen offset:1024 lds
    s_waitcnt lgkmcnt(6)
    v_mfma_f32_32x32x16_bf16 v[64:79], v[152:155], v[144:147], v[64:79]
    ds_read_b128 v[128:131], v49 offset:8192
    ds_read_b64_tr_b16 v[136:137], v51 offset:12288
    ds_read_b64_tr_b16 v[138:139], v51 offset:12800
    ds_read_b128 v[132:135], v49 offset:12288
    v_mfma_f32_32x32x16_bf16 v[80:95], v[152:155], v[148:151], v[80:95]
    ds_read_b64_tr_b16 v[140:141], v52 offset:12288
    ds_read_b64_tr_b16 v[142:143], v52 offset:12800
    s_add_u32 s90, s90, 65536
    s_add_u32 m0, s43, 40960
    s_mul_i32 s91, s13, 196608
    v_mfma_f32_32x32x16_bf16 v[96:111], v[156:159], v[144:147], v[96:111]
    buffer_load_dwordx4 v43, s[44:47], s90 offen lds
    buffer_load_dwordx4 v44, s[44:47], s90 offen offset:1024 lds
    s_add_u32 m0, s43, 81920
    s_add_u32 s90, s91, s15
    v_mfma_f32_32x32x16_bf16 v[112:127], v[156:159], v[148:151], v[112:127]
    buffer_load_dwordx4 v45, s[48:51], s90 offen lds
    buffer_load_dwordx4 v46, s[48:51], s90 offen offset:1024 lds
    s_waitcnt lgkmcnt(6)
    v_mfma_f32_32x32x16_bf16 v[64:79], v[168:171], v[160:163], v[64:79]
    ds_read_b128 v[144:147], v50 offset:8192
    ds_read_b64_tr_b16 v[152:153], v51 offset:14336
    ds_read_b64_tr_b16 v[154:155], v51 offset:14848
    v_mfma_f32_32x32x16_bf16 v[80:95], v[168:171], v[164:167], v[80:95]
    ds_read_b128 v[148:151], v50 offset:12288
    ds_read_b64_tr_b16 v[156:157], v52 offset:14336
    ds_read_b64_tr_b16 v[158:159], v52 offset:14848
    s_add_u32 m0, s43, 122880
    v_mfma_f32_32x32x16_bf16 v[96:111], v[172:175], v[160:163], v[96:111]
    s_add_u32 s90, s91, s42
    buffer_load_dwordx4 v45, s[48:51], s90 offen lds
    v_mfma_f32_32x32x16_bf16 v[112:127], v[172:175], v[164:167], v[112:127]
    buffer_load_dwordx4 v46, s[48:51], s90 offen offset:1024 lds
    s_add_u32 s13, s13, 1
    s_and_b32 s13, s13, 7
    s_waitcnt vmcnt(24) lgkmcnt(0)
    s_barrier
    v_mfma_f32_32x32x16_bf16 v[64:79], v[136:139], v[128:131], v[64:79]
    ds_read_b128 v[160:163], v47 offset:16384
    ds_read_b64_tr_b16 v[168:169], v51 offset:16384
    ds_read_b64_tr_b16 v[170:171], v51 offset:16896
    ds_read_b128 v[164:167], v47 offset:20480
    ds_read_b64_tr_b16 v[172:173], v52 offset:16384
    v_mfma_f32_32x32x16_bf16 v[80:95], v[136:139], v[132:135], v[80:95]
    ds_read_b64_tr_b16 v[174:175], v52 offset:16896
    s_lshl_b32 s90, s13, 7
    s_add_u32 s90, s90, s14
    s_add_u32 m0, s43, 8192
    s_mul_i32 s91, s13, 196608
    v_mfma_f32_32x32x16_bf16 v[96:111], v[140:143], v[128:131], v[96:111]
    buffer_load_dwordx4 v43, s[44:47], s90 offen lds
    buffer_load_dwordx4 v44, s[44:47], s90 offen offset:1024 lds
    s_add_u32 s90, s90, 65536
    s_add_u32 m0, s43, 49152
    v_mfma_f32_32x32x16_bf16 v[112:127], v[140:143], v[132:135], v[112:127]
    s_mul_i32 s91, s13, 196608
    buffer_load_dwordx4 v43, s[44:47], s90 offen lds
    buffer_load_dwordx4 v44, s[44:47], s90 offen offset:1024 lds
    v_mfma_f32_32x32x16_bf16 v[64:79], v[152:155], v[144:147], v[64:79]
    ds_read_b128 v[128:131], v48 offset:16384
    ds_read_b64_tr_b16 v[136:137], v51 offset:18432
    ds_read_b64_tr_b16 v[138:139], v51 offset:18944
    ds_read_b128 v[132:135], v48 offset:20480
    ds_read_b64_tr_b16 v[140:141], v52 offset:18432
    v_mfma_f32_32x32x16_bf16 v[80:95], v[152:155], v[148:151], v[80:95]
    ds_read_b64_tr_b16 v[142:143], v52 offset:18944
    s_add_u32 m0, s43, 90112
    s_add_u32 s90, s91, s15
    buffer_load_dwordx4 v45, s[48:51], s90 offen lds
    v_mfma_f32_32x32x16_bf16 v[96:111], v[156:159], v[144:147], v[96:111]
    buffer_load_dwordx4 v46, s[48:51], s90 offen offset:1024 lds
    s_add_u32 m0, s43, 131072
    s_add_u32 s90, s91, s42
    v_mfma_f32_32x32x16_bf16 v[112:127], v[156:159], v[148:151], v[112:127]
    buffer_load_dwordx4 v45, s[48:51], s90 offen lds
    buffer_load_dwordx4 v46, s[48:51], s90 offen offset:1024 lds
    s_add_u32 s13, s13, 1
    s_and_b32 s13, s13, 7
    s_waitcnt lgkmcnt(6)
    v_mfma_f32_32x32x16_bf16 v[64:79], v[168:171], v[160:163], v[64:79]
    ds_read_b128 v[144:147], v49 offset:16384
    ds_read_b64_tr_b16 v[152:153], v51 offset:20480
    v_mfma_f32_32x32x16_bf16 v[80:95], v[168:171], v[164:167], v[80:95]
    ds_read_b64_tr_b16 v[154:155], v51 offset:20992
    v_mfma_f32_32x32x16_bf16 v[96:111], v[172:175], v[160:163], v[96:111]
    ds_read_b128 v[148:151], v49 offset:20480
    ds_read_b64_tr_b16 v[156:157], v52 offset:20480
    v_mfma_f32_32x32x16_bf16 v[112:127], v[172:175], v[164:167], v[112:127]
    ds_read_b64_tr_b16 v[158:159], v52 offset:20992
    s_waitcnt lgkmcnt(6)
    v_mfma_f32_32x32x16_bf16 v[64:79], v[136:139], v[128:131], v[64:79]
    ds_read_b128 v[160:163], v50 offset:16384
    ds_read_b64_tr_b16 v[168:169], v51 offset:22528
    v_mfma_f32_32x32x16_bf16 v[80:95], v[136:139], v[132:135], v[80:95]
    ds_read_b64_tr_b16 v[170:171], v51 offset:23040
    v_mfma_f32_32x32x16_bf16 v[96:111], v[140:143], v[128:131], v[96:111]
    ds_read_b128 v[164:167], v50 offset:20480
    ds_read_b64_tr_b16 v[172:173], v52 offset:22528
    v_mfma_f32_32x32x16_bf16 v[112:127], v[140:143], v[132:135], v[112:127]
    ds_read_b64_tr_b16 v[174:175], v52 offset:23040
    s_waitcnt vmcnt(24) lgkmcnt(0)
    s_barrier
    v_mfma_f32_32x32x16_bf16 v[64:79], v[152:155], v[144:147], v[64:79]
    ds_read_b128 v[128:131], v47 offset:24576
    ds_read_b64_tr_b16 v[136:137], v51 offset:24576
    ds_read_b64_tr_b16 v[138:139], v51 offset:25088
    v_mfma_f32_32x32x16_bf16 v[80:95], v[152:155], v[148:151], v[80:95]
    ds_read_b128 v[132:135], v47 offset:28672
    ds_read_b64_tr_b16 v[140:141], v52 offset:24576
    ds_read_b64_tr_b16 v[142:143], v52 offset:25088
    s_lshl_b32 s90, s13, 7
    v_mfma_f32_32x32x16_bf16 v[96:111], v[156:159], v[144:147], v[96:111]
    s_add_u32 s90, s90, s14
    s_add_u32 m0, s43, 16384
    s_mul_i32 s91, s13, 196608
    v_mfma_f32_32x32x16_bf16 v[112:127], v[156:159], v[148:151], v[112:127]
    buffer_load_dwordx4 v43, s[44:47], s90 offen lds
    buffer_load_dwordx4 v44, s[44:47], s90 offen offset:1024 lds
    v_mfma_f32_32x32x16_bf16 v[64:79], v[168:171], v[160:163], v[64:79]
    ds_read_b128 v[144:147], v48 offset:24576
    ds_read_b64_tr_b16 v[152:153], v51 offset:26624
    ds_read_b64_tr_b16 v[154:155], v51 offset:27136
    v_mfma_f32_32x32x16_bf16 v[80:95], v[168:171], v[164:167], v[80:95]
    ds_read_b128 v[148:151], v48 offset:28672
    ds_read_b64_tr_b16 v[156:157], v52 offset:26624
    ds_read_b64_tr_b16 v[158:159], v52 offset:27136
    v_mfma_f32_32x32x16_bf16 v[96:111], v[172:175], v[160:163], v[96:111]
    s_add_u32 s90, s90, 65536
    s_add_u32 m0, s43, 57344
    s_mul_i32 s91, s13, 196608
    buffer_load_dwordx4 v43, s[44:47], s90 offen lds
    v_mfma_f32_32x32x16_bf16 v[112:127], v[172:175], v[164:167], v[112:127]
    buffer_load_dwordx4 v44, s[44:47], s90 offen offset:1024 lds
    s_waitcnt lgkmcnt(6)
    v_mfma_f32_32x32x16_bf16 v[64:79], v[136:139], v[128:131], v[64:79]
    ds_read_b128 v[160:163], v49 offset:24576
    ds_read_b64_tr_b16 v[168:169], v51 offset:28672
    ds_read_b64_tr_b16 v[170:171], v51 offset:29184
    v_mfma_f32_32x32x16_bf16 v[80:95], v[136:139], v[132:135], v[80:95]
    ds_read_b128 v[164:167], v49 offset:28672
    ds_read_b64_tr_b16 v[172:173], v52 offset:28672
    ds_read_b64_tr_b16 v[174:175], v52 offset:29184
    v_mfma_f32_32x32x16_bf16 v[96:111], v[140:143], v[128:131], v[96:111]
    s_add_u32 m0, s43, 98304
    s_add_u32 s90, s91, s15
    buffer_load_dwordx4 v45, s[48:51], s90 offen lds
    v_mfma_f32_32x32x16_bf16 v[112:127], v[140:143], v[132:135], v[112:127]
    buffer_load_dwordx4 v46, s[48:51], s90 offen offset:1024 lds
    s_waitcnt lgkmcnt(6)
    v_mfma_f32_32x32x16_bf16 v[64:79], v[152:155], v[144:147], v[64:79]
    ds_read_b128 v[128:131], v50 offset:24576
    ds_read_b64_tr_b16 v[136:137], v51 offset:30720
    ds_read_b64_tr_b16 v[138:139], v51 offset:31232
    v_mfma_f32_32x32x16_bf16 v[80:95], v[152:155], v[148:151], v[80:95]
    ds_read_b128 v[132:135], v50 offset:28672
    ds_read_b64_tr_b16 v[140:141], v52 offset:30720
    ds_read_b64_tr_b16 v[142:143], v52 offset:31232
    s_add_u32 m0, s43, 139264
    v_mfma_f32_32x32x16_bf16 v[96:111], v[156:159], v[144:147], v[96:111]
    s_add_u32 s90, s91, s42
    buffer_load_dwordx4 v45, s[48:51], s90 offen lds
    v_mfma_f32_32x32x16_bf16 v[112:127], v[156:159], v[148:151], v[112:127]
    buffer_load_dwordx4 v46, s[48:51], s90 offen offset:1024 lds
    s_add_u32 s13, s13, 1
    s_and_b32 s13, s13, 7
    s_waitcnt vmcnt(16) lgkmcnt(0)
    s_barrier
    v_readfirstlane_b32 s4, v8
    s_nop 0
    s_mul_i32 s4, s4, 0x0019660D
    s_add_u32 s4, s4, 0x3C6EF35F
    ds_read_b64_tr_b16 v[56:57], v41 offset:38912
    ds_read_b64_tr_b16 v[58:59], v41 offset:39168
    ds_read_b64_tr_b16 v[60:61], v41 offset:39936
    ds_read_b64_tr_b16 v[62:63], v41 offset:40192
    v_mfma_f32_32x32x16_bf16 v[64:79], v[168:171], v[160:163], v[64:79]
    ds_read_b128 v[144:147], v47 offset:0
    ds_read_b64_tr_b16 v[152:153], v51 offset:0
    ds_read_b64_tr_b16 v[154:155], v51 offset:512
    v_mfma_f32_32x32x16_bf16 v[80:95], v[168:171], v[164:167], v[80:95]
    ds_read_b128 v[148:151], v47 offset:4096
    ds_read_b64_tr_b16 v[156:157], v52 offset:0
    ds_read_b64_tr_b16 v[158:159], v52 offset:512
    s_lshl_b32 s90, s13, 7
    v_mfma_f32_32x32x16_bf16 v[96:111], v[172:175], v[160:163], v[96:111]
    s_add_u32 s90, s90, s14
    s_add_u32 m0, s43, 24576
    s_mul_i32 s91, s13, 196608
    v_mfma_f32_32x32x16_bf16 v[112:127], v[172:175], v[164:167], v[112:127]
    buffer_load_dwordx4 v43, s[44:47], s90 offen lds
    buffer_load_dwordx4 v44, s[44:47], s90 offen offset:1024 lds
    v_mfma_f32_32x32x16_bf16 v[64:79], v[136:139], v[128:131], v[64:79]
    ds_read_b128 v[160:163], v48 offset:0
    ds_read_b64_tr_b16 v[168:169], v51 offset:2048
    ds_read_b64_tr_b16 v[170:171], v51 offset:2560
    v_mfma_f32_32x32x16_bf16 v[80:95], v[136:139], v[132:135], v[80:95]
    ds_read_b128 v[164:167], v48 offset:4096
    ds_read_b64_tr_b16 v[172:173], v52 offset:2048
    ds_read_b64_tr_b16 v[174:175], v52 offset:2560
    v_mfma_f32_32x32x16_bf16 v[96:111], v[140:143], v[128:131], v[96:111]
    s_add_u32 s90, s90, 65536
    s_add_u32 m0, s43, 65536
    s_mul_i32 s91, s13, 196608
    buffer_load_dwordx4 v43, s[44:47], s90 offen lds
    v_mfma_f32_32x32x16_bf16 v[112:127], v[140:143], v[132:135], v[112:127]
    buffer_load_dwordx4 v44, s[44:47], s90 offen offset:1024 lds
    s_waitcnt lgkmcnt(6)
    v_mfma_f32_32x32x16_bf16 v[64:79], v[152:155], v[144:147], v[64:79]
    ds_read_b128 v[128:131], v49 offset:0
    ds_read_b64_tr_b16 v[136:137], v51 offset:4096
    ds_read_b64_tr_b16 v[138:139], v51 offset:4608
    v_mfma_f32_32x32x16_bf16 v[80:95], v[152:155], v[148:151], v[80:95]
    ds_read_b128 v[132:135], v49 offset:4096
    ds_read_b64_tr_b16 v[140:141], v52 offset:4096
    ds_read_b64_tr_b16 v[142:143], v52 offset:4608
    v_mfma_f32_32x32x16_bf16 v[96:111], v[156:159], v[144:147], v[96:111]
    s_add_u32 m0, s43, 106496
    s_add_u32 s90, s91, s15
    buffer_load_dwordx4 v45, s[48:51], s90 offen lds
    v_mfma_f32_32x32x16_bf16 v[112:127], v[156:159], v[148:151], v[112:127]
    buffer_load_dwordx4 v46, s[48:51], s90 offen offset:1024 lds
    s_waitcnt lgkmcnt(6)
    v_mfma_f32_32x32x16_bf16 v[64:79], v[168:171], v[160:163], v[64:79]
    ds_read_b128 v[144:147], v50 offset:0
    ds_read_b64_tr_b16 v[152:153], v51 offset:6144
    ds_read_b64_tr_b16 v[154:155], v51 offset:6656
    v_mfma_f32_32x32x16_bf16 v[80:95], v[168:171], v[164:167], v[80:95]
    ds_read_b128 v[148:151], v50 offset:4096
    ds_read_b64_tr_b16 v[156:157], v52 offset:6144
    ds_read_b64_tr_b16 v[158:159], v52 offset:6656
    s_add_u32 m0, s43, 147456
    v_mfma_f32_32x32x16_bf16 v[96:111], v[172:175], v[160:163], v[96:111]
    s_add_u32 s90, s91, s42
    buffer_load_dwordx4 v45, s[48:51], s90 offen lds
    v_mfma_f32_32x32x16_bf16 v[112:127], v[172:175], v[164:167], v[112:127]
    buffer_load_dwordx4 v46, s[48:51], s90 offen offset:1024 lds
    s_add_u32 s13, s13, 1
    s_and_b32 s13, s13, 7
    s_waitcnt vmcnt(16) lgkmcnt(0)
    s_barrier
    v_mfma_f32_32x32x16_bf16 v[64:79], v[136:139], v[128:131], v[64:79]
    ds_read_b128 v[160:163], v47 offset:8192
    ds_read_b64_tr_b16 v[168:169], v51 offset:8192
    ds_read_b64_tr_b16 v[170:171], v51 offset:8704
    v_mfma_f32_32x32x16_bf16 v[80:95], v[136:139], v[132:135], v[80:95]
    ds_read_b128 v[164:167], v47 offset:12288
    ds_read_b64_tr_b16 v[172:173], v52 offset:8192
    ds_read_b64_tr_b16 v[174:175], v52 offset:8704
    v_mfma_f32_32x32x16_bf16 v[96:111], v[140:143], v[128:131], v[96:111]
    s_add_u32 m0, s20, 0
    s_add_u32 s16, s26, 0
    buffer_load_dwordx4 v11, s[60:63], s16 offen lds
    v_mfma_f32_32x32x16_bf16 v[112:127], v[140:143], v[132:135], v[112:127]
    buffer_load_dwordx4 v12, s[60:63], s16 offen offset:1024 lds
    v_mfma_f32_32x32x16_bf16 v[64:79], v[152:155], v[144:147], v[64:79]
    ds_read_b128 v[128:131], v48 offset:8192
    ds_read_b64_tr_b16 v[136:137], v51 offset:10240
    ds_read_b64_tr_b16 v[138:139], v51 offset:10752
    v_mfma_f32_32x32x16_bf16 v[80:95], v[152:155], v[148:151], v[80:95]
    ds_read_b128 v[132:135], v48 offset:12288
    ds_read_b64_tr_b16 v[140:141], v52 offset:10240
    ds_read_b64_tr_b16 v[142:143], v52 offset:10752
    v_mfma_f32_32x32x16_bf16 v[96:111], v[156:159], v[144:147], v[96:111]
    s_add_u32 m0, s20, 2048
    s_add_u32 s16, s26, 57344
    buffer_load_dwordx4 v11, s[60:63], s16 offen lds
    v_mfma_f32_32x32x16_bf16 v[112:127], v[156:159], v[148:151], v[112:127]
    buffer_load_dwordx4 v12, s[60:63], s16 offen offset:1024 lds
    s_waitcnt lgkmcnt(6)
    v_mfma_f32_32x32x16_bf16 v[64:79], v[168:171], v[160:163], v[64:79]
    ds_read_b128 v[144:147], v49 offset:8192
    ds_read_b64_tr_b16 v[152:153], v51 offset:12288
    ds_read_b64_tr_b16 v[154:155], v51 offset:12800
    v_mfma_f32_32x32x16_bf16 v[80:95], v[168:171], v[164:167], v[80:95]
    ds_read_b128 v[148:151], v49 offset:12288
    ds_read_b64_tr_b16 v[156:157], v52 offset:12288
    ds_read_b64_tr_b16 v[158:159], v52 offset:12800
    v_mfma_f32_32x32x16_bf16 v[96:111], v[172:175], v[160:163], v[96:111]
    s_add_u32 m0, s20, 4096
    s_add_u32 s16, s26, 114688
    buffer_load_dwordx4 v11, s[60:63], s16 offen lds
    v_mfma_f32_32x32x16_bf16 v[112:127], v[172:175], v[164:167], v[112:127]
    buffer_load_dwordx4 v12, s[60:63], s16 offen offset:1024 lds
    s_waitcnt lgkmcnt(6)
    v_mfma_f32_32x32x16_bf16 v[64:79], v[136:139], v[128:131], v[64:79]
    ds_read_b128 v[160:163], v50 offset:8192
    ds_read_b64_tr_b16 v[168:169], v51 offset:14336
    ds_read_b64_tr_b16 v[170:171], v51 offset:14848
    v_mfma_f32_32x32x16_bf16 v[80:95], v[136:139], v[132:135], v[80:95]
    ds_read_b128 v[164:167], v50 offset:12288
    ds_read_b64_tr_b16 v[172:173], v52 offset:14336
    ds_read_b64_tr_b16 v[174:175], v52 offset:14848
    v_mfma_f32_32x32x16_bf16 v[96:111], v[140:143], v[128:131], v[96:111]
    s_add_u32 m0, s20, 6144
    s_add_u32 s16, s26, 172032
    buffer_load_dwordx4 v11, s[60:63], s16 offen lds
    v_mfma_f32_32x32x16_bf16 v[112:127], v[140:143], v[132:135], v[112:127]
    buffer_load_dwordx4 v12, s[60:63], s16 offen offset:1024 lds
    s_waitcnt vmcnt(16) lgkmcnt(0)
    s_barrier
    v_mfma_f32_32x32x16_bf16 v[64:79], v[152:155], v[144:147], v[64:79]
    ds_read_b128 v[128:131], v47 offset:16384
    ds_read_b64_tr_b16 v[136:137], v51 offset:16384
    ds_read_b64_tr_b16 v[138:139], v51 offset:16896
    ds_read_b128 v[132:135], v47 offset:20480
    v_mfma_f32_32x32x16_bf16 v[80:95], v[152:155], v[148:151], v[80:95]
    ds_read_b64_tr_b16 v[140:141], v52 offset:16384
    ds_read_b64_tr_b16 v[142:143], v52 offset:16896
    s_add_u32 m0, s20, 8192
    s_add_u32 s16, s26, 229376
    v_mfma_f32_32x32x16_bf16 v[96:111], v[156:159], v[144:147], v[96:111]
    buffer_load_dwordx4 v11, s[60:63], s16 offen lds
    buffer_load_dwordx4 v12, s[60:63], s16 offen offset:1024 lds
    s_waitcnt vmcnt(8)
    v_mfma_f32_32x32x16_bf16 v[112:127], v[156:159], v[148:151], v[112:127]
    ds_read_b64_tr_b16 a[0:1], v13 offset:0
    ds_read_b64_tr_b16 a[2:3], v13 offset:512
    ds_read_b64_tr_b16 a[4:5], v14 offset:0
    ds_read_b64_tr_b16 a[6:7], v14 offset:512
    v_mfma_f32_32x32x16_bf16 v[64:79], v[168:171], v[160:163], v[64:79]
    ds_read_b128 v[144:147], v48 offset:16384
    ds_read_b64_tr_b16 v[152:153], v51 offset:18432
    ds_read_b64_tr_b16 v[154:155], v51 offset:18944
    ds_read_b128 v[148:151], v48 offset:20480
    v_mfma_f32_32x32x16_bf16 v[80:95], v[168:171], v[164:167], v[80:95]
    ds_read_b64_tr_b16 v[156:157], v52 offset:18432
    ds_read_b64_tr_b16 v[158:159], v52 offset:18944
    s_add_u32 m0, s20, 10240
    s_add_u32 s16, s26, 286720
    v_mfma_f32_32x32x16_bf16 v[96:111], v[172:175], v[160:163], v[96:111]
    buffer_load_dwordx4 v11, s[60:63], s16 offen lds
    buffer_load_dwordx4 v12, s[60:63], s16 offen offset:1024 lds
    s_waitcnt vmcnt(8)
    v_mfma_f32_32x32x16_bf16 v[112:127], v[172:175], v[164:167], v[112:127]
    ds_read_b64_tr_b16 a[8:9], v13 offset:2048
    ds_read_b64_tr_b16 a[10:11], v13 offset:2560
    ds_read_b64_tr_b16 a[12:13], v14 offset:2048
    ds_read_b64_tr_b16 a[14:15], v14 offset:2560
    s_waitcnt lgkmcnt(14)
    buffer_load_dword v8, v9, s[84:87], s38 offen sc1
    v_mfma_f32_32x32x16_bf16 v[64:79], v[136:139], v[128:131], v[64:79]
    ds_read_b128 v[160:163], v49 offset:16384
    ds_read_b64_tr_b16 v[168:169], v51 offset:20480
    ds_read_b64_tr_b16 v[170:171], v51 offset:20992
    ds_read_b128 v[164:167], v49 offset:20480
    ds_read_b64_tr_b16 v[172:173], v52 offset:20480
    ds_read_b64_tr_b16 v[174:175], v52 offset:20992
    s_add_u32 m0, s20, 12288
    v_mfma_f32_32x32x16_bf16 v[80:95], v[136:139], v[132:135], v[80:95]
    s_add_u32 s16, s26, 344064
    buffer_load_dwordx4 v11, s[60:63], s16 offen lds
    buffer_load_dwordx4 v12, s[60:63], s16 offen offset:1024 lds
    s_waitcnt vmcnt(9)
    ds_read_b64_tr_b16 a[16:17], v13 offset:4096
    v_mfma_f32_32x32x16_bf16 v[96:111], v[140:143], v[128:131], v[96:111]
    ds_read_b64_tr_b16 a[18:19], v13 offset:4608
    ds_read_b64_tr_b16 a[20:21], v14 offset:4096
    ds_read_b64_tr_b16 a[22:23], v14 offset:4608
    s_add_u32 m0, s20, 14336
    s_add_u32 s16, s26, 401408
    buffer_load_dwordx4 v11, s[60:63], s16 offen lds
    v_mfma_f32_32x32x16_bf16 v[112:127], v[140:143], v[132:135], v[112:127]
    buffer_load_dwordx4 v12, s[60:63], s16 offen offset:1024 lds
    s_waitcnt vmcnt(9)
    ds_read_b64_tr_b16 a[24:25], v13 offset:6144
    ds_read_b64_tr_b16 a[26:27], v13 offset:6656
    ds_read_b64_tr_b16 a[28:29], v14 offset:6144
    ds_read_b64_tr_b16 a[30:31], v14 offset:6656
    s_waitcnt lgkmcnt(15)
    v_mfma_f32_32x32x16_bf16 v[64:79], v[152:155], v[144:147], v[64:79]
    ds_read_b128 v[128:131], v50 offset:16384
    ds_read_b64_tr_b16 v[136:137], v51 offset:22528
    ds_read_b64_tr_b16 v[138:139], v51 offset:23040
    ds_read_b128 v[132:135], v50 offset:20480
    v_mfma_f32_32x32x16_bf16 v[80:95], v[152:155], v[148:151], v[80:95]
    ds_read_b64_tr_b16 v[140:141], v52 offset:22528
    ds_read_b64_tr_b16 v[142:143], v52 offset:23040
    s_add_u32 m0, s20, 0
    s_add_u32 s16, s26, 458752
    v_mfma_f32_32x32x16_bf16 v[96:111], v[156:159], v[144:147], v[96:111]
    buffer_load_dwordx4 v11, s[60:63], s16 offen lds
    buffer_load_dwordx4 v12, s[60:63], s16 offen offset:1024 lds
    s_waitcnt vmcnt(9)
    v_mfma_f32_32x32x16_bf16 v[112:127], v[156:159], v[148:151], v[112:127]
    ds_read_b64_tr_b16 a[32:33], v13 offset:8192
    ds_read_b64_tr_b16 a[34:35], v13 offset:8704
    ds_read_b64_tr_b16 a[36:37], v14 offset:8192
    ds_read_b64_tr_b16 a[38:39], v14 offset:8704
    s_waitcnt lgkmcnt(4)
    s_barrier
    v_mfma_f32_32x32x16_bf16 v[64:79], v[168:171], v[160:163], v[64:79]
    ds_read_b128 v[144:147], v47 offset:24576
    ds_read_b64_tr_b16 v[152:153], v51 offset:24576
    ds_read_b64_tr_b16 v[154:155], v51 offset:25088
    ds_read_b128 v[148:151], v47 offset:28672
    v_mfma_f32_32x32x16_bf16 v[80:95], v[168:171], v[164:167], v[80:95]
    ds_read_b64_tr_b16 v[156:157], v52 offset:24576
    ds_read_b64_tr_b16 v[158:159], v52 offset:25088
    s_add_u32 m0, s20, 2048
    s_add_u32 s16, s26, 516096
    v_mfma_f32_32x32x16_bf16 v[96:111], v[172:175], v[160:163], v[96:111]
    buffer_load_dwordx4 v11, s[60:63], s16 offen lds
    buffer_load_dwordx4 v12, s[60:63], s16 offen offset:1024 lds
    s_waitcnt vmcnt(9)
    v_mfma_f32_32x32x16_bf16 v[112:127], v[172:175], v[164:167], v[112:127]
    ds_read_b64_tr_b16 a[40:41], v13 offset:10240
    ds_read_b64_tr_b16 a[42:43], v13 offset:10752
    ds_read_b64_tr_b16 a[44:45], v14 offset:10240
    ds_read_b64_tr_b16 a[46:47], v14 offset:10752
    s_waitcnt vmcnt(8)
    v_cmp_ne_u32 vcc, s4, v8
    s_mov_b32 s19, 0x40000
    s_cmp_lg_u64 vcc, 0
    s_cbranch_scc1 L_spin1
L_go1:
    v_mfma_f32_32x32x16_bf16 v[64:79], v[136:139], v[128:131], v[64:79]
    ds_read_b128 v[160:163], v48 offset:24576
    ds_read_b64_tr_b16 v[168:169], v51 offset:26624
    ds_read_b64_tr_b16 v[170:171], v51 offset:27136
    ds_read_b128 v[164:167], v48 offset:28672
    v_mfma_f32_32x32x16_bf16 v[80:95], v[136:139], v[132:135], v[80:95]
    ds_read_b64_tr_b16 v[172:173], v52 offset:26624
    ds_read_b64_tr_b16 v[174:175], v52 offset:27136
    s_add_u32 s17, s25, 0
    buffer_load_dwordx4 a[48:51], v15, s[84:87], s17 offen sc1
    v_mfma_f32_32x32x16_bf16 v[96:111], v[140:143], v[128:131], v[96:111]
    buffer_load_dwordx4 a[52:55], v16, s[84:87], s17 offen sc1
    s_waitcnt vmcnt(8)
    v_mfma_f32_32x32x16_bf16 v[112:127], v[140:143], v[132:135], v[112:127]
    ds_read_b64_tr_b16 a[56:57], v13 offset:12288
    ds_read_b64_tr_b16 a[58:59], v13 offset:12800
    ds_read_b64_tr_b16 a[60:61], v14 offset:12288
    ds_read_b64_tr_b16 a[62:63], v14 offset:12800
    s_waitcnt lgkmcnt(14)
    v_mfma_f32_32x32x16_bf16 v[64:79], v[152:155], v[144:147], v[64:79]
    ds_read_b128 v[128:131], v49 offset:24576
    ds_read_b64_tr_b16 v[136:137], v51 offset:28672
    ds_read_b64_tr_b16 v[138:139], v51 offset:29184
    ds_read_b128 v[132:135], v49 offset:28672
    v_mfma_f32_32x32x16_bf16 v[80:95], v[152:155], v[148:151], v[80:95]
    ds_read_b64_tr_b16 v[140:141], v52 offset:28672
    ds_read_b64_tr_b16 v[142:143], v52 offset:29184
    s_add_u32 s17, s25, 2048
    buffer_load_dwordx4 a[64:67], v15, s[84:87], s17 offen sc1
    v_mfma_f32_32x32x16_bf16 v[96:111], v[156:159], v[144:147], v[96:111]
    buffer_load_dwordx4 a[68:71], v16, s[84:87], s17 offen sc1
    s_waitcnt vmcnt(8)
    v_mfma_f32_32x32x16_bf16 v[112:127], v[156:159], v[148:151], v[112:127]
    ds_read_b64_tr_b16 a[72:73], v13 offset:14336
    ds_read_b64_tr_b16 a[74:75], v13 offset:14848
    ds_read_b64_tr_b16 a[76:77], v14 offset:14336
    ds_read_b64_tr_b16 a[78:79], v14 offset:14848
    s_waitcnt lgkmcnt(14)
    v_mfma_f32_32x32x16_bf16 v[64:79], v[168:171], v[160:163], v[64:79]
    ds_read_b128 v[144:147], v50 offset:24576
    ds_read_b64_tr_b16 v[152:153], v51 offset:30720
    ds_read_b64_tr_b16 v[154:155], v51 offset:31232
    ds_read_b128 v[148:151], v50 offset:28672
    v_mfma_f32_32x32x16_bf16 v[80:95], v[168:171], v[164:167], v[80:95]
    ds_read_b64_tr_b16 v[156:157], v52 offset:30720
    ds_read_b64_tr_b16 v[158:159], v52 offset:31232
    s_add_u32 s17, s25, 4096
    buffer_load_dwordx4 a[80:83], v15, s[84:87], s17 offen sc1
    v_mfma_f32_32x32x16_bf16 v[96:111], v[172:175], v[160:163], v[96:111]
    buffer_load_dwordx4 a[84:87], v16, s[84:87], s17 offen sc1
    s_waitcnt vmcnt(8)
    v_mfma_f32_32x32x16_bf16 v[112:127], v[172:175], v[164:167], v[112:127]
    ds_read_b64_tr_b16 a[88:89], v13 offset:0
    ds_read_b64_tr_b16 a[90:91], v13 offset:512
    ds_read_b64_tr_b16 a[92:93], v14 offset:0
    ds_read_b64_tr_b16 a[94:95], v14 offset:512
    s_waitcnt lgkmcnt(14)
    v_mfma_f32_32x32x16_bf16 v[64:79], v[136:139], v[128:131], v[64:79]
    s_add_u32 s17, s25, 6144
    buffer_load_dwordx4 a[96:99], v15, s[84:87], s17 offen sc1
    v_mfma_f32_32x32x16_bf16 v[80:95], v[136:139], v[132:135], v[80:95]
    buffer_load_dwordx4 a[100:103], v16, s[84:87], s17 offen sc1
    s_waitcnt vmcnt(8)
    ds_read_b64_tr_b16 a[104:105], v13 offset:2048
    ds_read_b64_tr_b16 a[106:107], v13 offset:2560
    v_mfma_f32_32x32x16_bf16 v[96:111], v[140:143], v[128:131], v[96:111]
    ds_read_b64_tr_b16 a[108:109], v14 offset:2048
    ds_read_b64_tr_b16 a[110:111], v14 offset:2560
    s_add_u32 s17, s25, 8192
    v_mfma_f32_32x32x16_bf16 v[112:127], v[140:143], v[132:135], v[112:127]
    buffer_load_dwordx4 a[112:115], v15, s[84:87], s17 offen sc1
    buffer_load_dwordx4 a[116:119], v16, s[84:87], s17 offen sc1
    s_waitcnt lgkmcnt(8)
    s_barrier
    v_mfma_f32_32x32x16_bf16 v[64:79], v[152:155], v[144:147], v[64:79]
    s_add_u32 s17, s25, 10240
    v_mfma_f32_32x32x16_bf16 v[80:95], v[152:155], v[148:151], v[80:95]
    buffer_load_dwordx4 a[120:123], v15, s[84:87], s17 offen sc1
    v_mfma_f32_32x32x16_bf16 v[96:111], v[156:159], v[144:147], v[96:111]
    v_mfma_f32_32x32x16_bf16 v[112:127], v[156:159], v[148:151], v[112:127]
    buffer_load_dwordx4 a[124:127], v16, s[84:87], s17 offen sc1
    s_cmp_ge_u32 s97, 16
    s_cbranch_scc1 L_qepi
    v_bfe_u32 v2, v1, 2, 2
    v_lshrrev_b32 v3, 5, v1
    v_lshl_add_u32 v2, v3, 2, v2
    v_bfe_u32 v4, v1, 4, 1
    v_and_b32 v5, 3, v1
    v_lshlrev_b32 v5, 3, v5
    v_lshl_add_u32 v5, v4, 5, v5
    v_add_u32 v5, s20, v5
    v_mad_u32_u24 v46, v2, 36, 0
    v_lshl_add_u32 v46, v46, 1, v5
    v_mad_u32_u24 v2, v2, 34, 0
    v_cvt_pk_bf16_f32 v180, v64, v65
    v_cvt_pk_bf16_f32 v181, v66, v67
    v_cvt_pk_bf16_f32 v182, v68, v69
    v_cvt_pk_bf16_f32 v183, v70, v71
    v_cvt_pk_bf16_f32 v184, v72, v73
    v_cvt_pk_bf16_f32 v185, v74, v75
    v_cvt_pk_bf16_f32 v186, v76, v77
    v_cvt_pk_bf16_f32 v187, v78, v79
    v_lshl_add_u32 v45, v2, 2, v5
    v_and_b32 v2, 31, v1
    v_lshlrev_b32 v3, 3, v3
    v_add_u32 v3, s20, v3
    v_mad_u32_u24 v43, v2, 34, 0
    v_lshl_add_u32 v43, v43, 2, v3
    v_mad_u32_u24 v44, v2, 36, 0
    v_lshl_add_u32 v44, v44, 1, v3
    v_xor_b32 v47, 0x100, v6
    s_waitcnt lgkmcnt(0)
    v_cndmask_b32 v176, v56, 0, s[98:99]
    s_waitcnt vmcnt(10)
    v_mfma_f32_32x32x16_bf16 a[192:207], a[0:3], a[48:51], 0
    v_cndmask_b32 v60, 0, v56, s[98:99]
    v_cndmask_b32 v177, v57, 0, s[98:99]
    v_cndmask_b32 v61, 0, v57, s[98:99]
    v_cndmask_b32 v178, v58, 0, s[98:99]
    v_cndmask_b32 v62, 0, v58, s[98:99]
    v_cndmask_b32 v179, v59, 0, s[98:99]
    v_cndmask_b32 v63, 0, v59, s[98:99]
    v_mov_b32 v48, 0x3f803f80
    v_mfma_f32_32x32x16_bf16 v[64:79], v[176:179], v[180:183], 0
    s_add_u32 s17, s25, 12288
    buffer_load_dwordx4 a[128:131], v15, s[84:87], s17 offen sc1
    buffer_load_dwordx4 a[132:135], v16, s[84:87], s17 offen sc1
    v_mfma_f32_32x32x16_bf16 v[64:79], v[60:63], v[184:187], v[64:79]
    v_mfma_f32_32x32x16_bf16 a[208:223], a[0:3], a[52:55], 0
    v_cvt_pk_bf16_f32 v220, v80, v81
    v_cvt_pk_bf16_f32 v221, v82, v83
    v_cvt_pk_bf16_f32 v222, v84, v85
    v_cvt_pk_bf16_f32 v223, v86, v87
    v_cvt_pk_bf16_f32 v224, v88, v89
    v_cvt_pk_bf16_f32 v225, v90, v91
    v_cvt_pk_bf16_f32 v226, v92, v93
    v_cvt_pk_bf16_f32 v227, v94, v95
    v_mfma_f32_32x32x16_bf16 v[80:95], v[176:179], v[220:223], 0
    s_nop 0
    v_mfma_f32_32x32x16_bf16 v[80:95], v[60:63], v[224:227], v[80:95]
    v_mfma_f32_32x32x16_bf16 a[224:239], a[4:7], a[48:51], 0
    v_cvt_pk_bf16_f32 v180, v96, v97
    v_cvt_pk_bf16_f32 v181, v98, v99
    v_cvt_pk_bf16_f32 v182, v100, v101
    v_cvt_pk_bf16_f32 v183, v102, v103
    v_cvt_pk_bf16_f32 v184, v104, v105
    v_cvt_pk_bf16_f32 v185, v106, v107
    v_cvt_pk_bf16_f32 v186, v108, v109
    v_cvt_pk_bf16_f32 v187, v110, v111
    ds_write_b64 v44, v[180:181] offset:37120
    ds_write_b64 v44, v[182:183] offset:37136
    ds_write_b64 v44, v[184:185] offset:37152
    ds_write_b64 v44, v[186:187] offset:37168
    v_cvt_pk_bf16_f32 v204, v64, v65
    v_cvt_pk_bf16_f32 v205, v66, v67
    s_add_u32 s17, s25, 14336
    buffer_load_dwordx4 a[136:139], v15, s[84:87], s17 offen sc1
    buffer_load_dwordx4 a[140:143], v16, s[84:87], s17 offen sc1
    v_cvt_pk_bf16_f32 v206, v68, v69
    v_cvt_pk_bf16_f32 v207, v70, v71
    v_cvt_pk_bf16_f32 v208, v72, v73
    v_cvt_pk_bf16_f32 v209, v74, v75
    v_cvt_pk_bf16_f32 v210, v76, v77
    v_cvt_pk_bf16_f32 v211, v78, v79
    v_lshlrev_b32 v64, 16, v204
    v_and_b32 v65, 0xffff0000, v204
    v_lshlrev_b32 v66, 16, v205
    v_and_b32 v67, 0xffff0000, v205
    v_lshlrev_b32 v68, 16, v206
    v_and_b32 v69, 0xffff0000, v206
    v_mfma_f32_32x32x16_bf16 a[240:255], a[4:7], a[52:55], 0
    v_lshlrev_b32 v70, 16, v207
    v_and_b32 v71, 0xffff0000, v207
    v_lshlrev_b32 v72, 16, v208
    v_and_b32 v73, 0xffff0000, v208
    v_lshlrev_b32 v74, 16, v209
    v_and_b32 v75, 0xffff0000, v209
    v_lshlrev_b32 v76, 16, v210
    v_and_b32 v77, 0xffff0000, v210
    v_lshlrev_b32 v78, 16, v211
    v_and_b32 v79, 0xffff0000, v211
    v_max3_f32 v204, v64, v65, v66
    v_min3_f32 v208, v64, v65, v66
    v_max3_f32 v206, v72, v73, v74
    s_waitcnt vmcnt(12)
    v_mfma_f32_32x32x16_bf16 a[192:207], a[8:11], a[64:67], a[192:207]
    v_min3_f32 v210, v72, v73, v74
    v_max3_f32 v204, v204, v67, v68
    v_min3_f32 v208, v208, v67, v68
    v_max3_f32 v206, v206, v75, v76
    v_min3_f32 v210, v210, v75, v76
    v_max3_f32 v204, v204, v69, v70
    v_min3_f32 v208, v208, v69, v70
    v_max3_f32 v206, v206, v77, v78
    v_min3_f32 v210, v210, v77, v78
    v_max_f32 v204, v204, v71
    v_min_f32 v208, v208, v71
    v_max_f32 v206, v206, v79
    s_add_u32 s17, s25, 16384
    buffer_load_dwordx4 a[144:147], v15, s[84:87], s17 offen sc1
    buffer_load_dwordx4 a[148:151], v16, s[84:87], s17 offen sc1
    v_min_f32 v210, v210, v79
    v_permlane32_swap_b32 v204, v206
    s_nop 0
    v_permlane32_swap_b32 v208, v210
    v_max_f32 v204, v204, v206
    v_min_f32 v208, v208, v210
    v_mul_f32 v204, s94, v204
    v_mul_f32 v208, s94, v208
    v_mov_b32 v206, v204
    v_mov_b32 v210, v208
    s_nop 0
    v_permlane32_swap_b32 v204, v206
    v_mfma_f32_32x32x16_bf16 a[208:223], a[8:11], a[68:71], a[208:223]
    v_permlane32_swap_b32 v208, v210
    v_pk_fma_f32 v[188:189], v[64:65], s[94:95], v[208:209] op_sel_hi:[1,1,0] neg_lo:[1,0,0] neg_hi:[1,0,0]
    v_pk_fma_f32 v[64:65], v[64:65], s[94:95], v[204:205] op_sel_hi:[1,1,0] neg_lo:[0,0,1] neg_hi:[0,0,1]
    v_pk_fma_f32 v[190:191], v[66:67], s[94:95], v[208:209] op_sel_hi:[1,1,0] neg_lo:[1,0,0] neg_hi:[1,0,0]
    v_pk_fma_f32 v[66:67], v[66:67], s[94:95], v[204:205] op_sel_hi:[1,1,0] neg_lo:[0,0,1] neg_hi:[0,0,1]
    v_pk_fma_f32 v[192:193], v[68:69], s[94:95], v[208:209] op_sel_hi:[1,1,0] neg_lo:[1,0,0] neg_hi:[1,0,0]
    v_pk_fma_f32 v[68:69], v[68:69], s[94:95], v[204:205] op_sel_hi:[1,1,0] neg_lo:[0,0,1] neg_hi:[0,0,1]
    v_pk_fma_f32 v[194:195], v[70:71], s[94:95], v[208:209] op_sel_hi:[1,1,0] neg_lo:[1,0,0] neg_hi:[1,0,0]
    v_pk_fma_f32 v[70:71], v[70:71], s[94:95], v[204:205] op_sel_hi:[1,1,0] neg_lo:[0,0,1] neg_hi:[0,0,1]
    v_pk_fma_f32 v[196:197], v[72:73], s[94:95], v[210:211] op_sel_hi:[1,1,0] neg_lo:[1,0,0] neg_hi:[1,0,0]
    v_pk_fma_f32 v[72:73], v[72:73], s[94:95], v[206:207] op_sel_hi:[1,1,0] neg_lo:[0,0,1] neg_hi:[0,0,1]
    s_nop 1
    v_mfma_f32_32x32x16_bf16 a[224:239], a[12:15], a[64:67], a[224:239]
    v_pk_fma_f32 v[198:199], v[74:75], s[94:95], v[210:211] op_sel_hi:[1,1,0] neg_lo:[1,0,0] neg_hi:[1,0,0]
    v_pk_fma_f32 v[74:75], v[74:75], s[94:95], v[206:207] op_sel_hi:[1,1,0] neg_lo:[0,0,1] neg_hi:[0,0,1]
    v_pk_fma_f32 v[200:201], v[76:77], s[94:95], v[210:211] op_sel_hi:[1,1,0] neg_lo:[1,0,0] neg_hi:[1,0,0]
    v_pk_fma_f32 v[76:77], v[76:77], s[94:95], v[206:207] op_sel_hi:[1,1,0] neg_lo:[0,0,1] neg_hi:[0,0,1]
    v_pk_fma_f32 v[202:203], v[78:79], s[94:95], v[210:211] op_sel_hi:[1,1,0] neg_lo:[1,0,0] neg_hi:[1,0,0]
    v_pk_fma_f32 v[78:79], v[78:79], s[94:95], v[206:207] op_sel_hi:[1,1,0] neg_lo:[0,0,1] neg_hi:[0,0,1]
    v_exp_f32 v188, v188
    v_exp_f32 v64, v64
    v_exp_f32 v189, v189
    v_exp_f32 v65, v65
    s_add_u32 s17, s25, 18432
    buffer_load_dwordx4 a[152:155], v15, s[84:87], s17 offen sc1
    buffer_load_dwordx4 a[156:159], v16, s[84:87], s17 offen sc1
    v_exp_f32 v190, v190
    v_exp_f32 v66, v66
    v_exp_f32 v191, v191
    v_exp_f32 v67, v67
    v_exp_f32 v192, v192
    v_exp_f32 v68, v68
    v_mfma_f32_32x32x16_bf16 a[240:255], a[12:15], a[68:71], a[240:255]
    v_exp_f32 v193, v193
    v_exp_f32 v69, v69
    v_exp_f32 v194, v194
    v_exp_f32 v70, v70
    v_exp_f32 v195, v195
    v_exp_f32 v71, v71
    s_waitcnt vmcnt(14)
    v_mfma_f32_32x32x16_bf16 a[192:207], a[16:19], a[80:83], a[192:207]
    v_exp_f32 v196, v196
    v_exp_f32 v72, v72
    v_exp_f32 v197, v197
    v_exp_f32 v73, v73
    v_exp_f32 v198, v198
    v_exp_f32 v74, v74
    s_add_u32 s17, s25, 20480
    buffer_load_dwordx4 a[160:163], v15, s[84:87], s17 offen sc1
    buffer_load_dwordx4 a[164:167], v16, s[84:87], s17 offen sc1
    v_exp_f32 v199, v199
    v_exp_f32 v75, v75
    v_exp_f32 v200, v200
    v_exp_f32 v76, v76
    v_exp_f32 v201, v201
    v_exp_f32 v77, v77
    v_mfma_f32_32x32x16_bf16 a[208:223], a[16:19], a[84:87], a[208:223]
    v_exp_f32 v202, v202
    v_exp_f32 v78, v78
    v_exp_f32 v203, v203
    v_exp_f32 v79, v79
    v_pk_add_f32 v[204:205], v[64:65], v[66:67]
    v_pk_add_f32 v[212:213], v[68:69], v[70:71]
    v_pk_add_f32 v[208:209], v[188:189], v[190:191]
    v_pk_add_f32 v[216:217], v[192:193], v[194:195]
    v_pk_add_f32 v[206:207], v[72:73], v[74:75]
    s_nop 1
    v_mfma_f32_32x32x16_bf16 a[224:239], a[20:23], a[80:83], a[224:239]
    v_pk_add_f32 v[214:215], v[76:77], v[78:79]
    v_pk_add_f32 v[210:211], v[196:197], v[198:199]
    v_pk_add_f32 v[218:219], v[200:201], v[202:203]
    v_pk_add_f32 v[204:205], v[204:205], v[212:213]
    v_pk_add_f32 v[206:207], v[206:207], v[214:215]
    v_pk_add_f32 v[208:209], v[208:209], v[216:217]
    v_pk_add_f32 v[210:211], v[210:211], v[218:219]
    v_add_f32 v204, v204, v205
    v_add_f32 v206, v206, v207
    v_add_f32 v208, v208, v209
    v_add_f32 v210, v210, v211
    v_permlane32_swap_b32 v204, v206
    s_add_u32 m0, s20, 4096
    s_add_u32 s16, s26, 573440
    buffer_load_dwordx4 v11, s[60:63], s16 offen lds
    buffer_load_dwordx4 v12, s[60:63], s16 offen offset:1024 lds
    v_permlane32_swap_b32 v208, v210
    v_add_f32 v204, v204, v206
    v_add_f32 v208, v208, v210
    v_rcp_f32 v204, v204
    v_rcp_f32 v208, v208
    v_mov_b32 v206, v204
    v_mov_b32 v210, v208
    s_nop 0
    v_permlane32_swap_b32 v204, v206
    v_mfma_f32_32x32x16_bf16 a[240:255], a[20:23], a[84:87], a[240:255]
    v_permlane32_swap_b32 v208, v210
    v_pk_mul_f32 v[64:65], v[64:65], v[204:205] op_sel_hi:[1,0]
    v_pk_mul_f32 v[188:189], v[188:189], v[208:209] op_sel_hi:[1,0]
    v_pk_mul_f32 v[66:67], v[66:67], v[204:205] op_sel_hi:[1,0]
    v_pk_mul_f32 v[190:191], v[190:191], v[208:209] op_sel_hi:[1,0]
    v_pk_mul_f32 v[68:69], v[68:69], v[204:205] op_sel_hi:[1,0]
    v_pk_mul_f32 v[192:193], v[192:193], v[208:209] op_sel_hi:[1,0]
    v_pk_mul_f32 v[70:71], v[70:71], v[204:205] op_sel_hi:[1,0]
    v_pk_mul_f32 v[194:195], v[194:195], v[208:209] op_sel_hi:[1,0]
    v_pk_mul_f32 v[72:73], v[72:73], v[206:207] op_sel_hi:[1,0]
    v_pk_mul_f32 v[196:197], v[196:197], v[210:211] op_sel_hi:[1,0]
    s_waitcnt vmcnt(16)
    s_nop 0
    v_mfma_f32_32x32x16_bf16 a[192:207], a[24:27], a[96:99], a[192:207]
    v_pk_mul_f32 v[74:75], v[74:75], v[206:207] op_sel_hi:[1,0]
    v_pk_mul_f32 v[198:199], v[198:199], v[210:211] op_sel_hi:[1,0]
    v_pk_mul_f32 v[76:77], v[76:77], v[206:207] op_sel_hi:[1,0]
    v_pk_mul_f32 v[200:201], v[200:201], v[210:211] op_sel_hi:[1,0]
    v_pk_mul_f32 v[78:79], v[78:79], v[206:207] op_sel_hi:[1,0]
    v_pk_mul_f32 v[202:203], v[202:203], v[210:211] op_sel_hi:[1,0]
    v_cvt_pk_bf16_f32 v220, v64, v65
    v_cvt_pk_bf16_f32 v228, v188, v189
    v_cvt_pk_bf16_f32 v221, v66, v67
    v_cvt_pk_bf16_f32 v229, v190, v191
    v_cvt_pk_bf16_f32 v222, v68, v69
    v_cvt_pk_bf16_f32 v230, v192, v193
    s_add_u32 s17, s25, 22528
    buffer_load_dwordx4 a[168:171], v15, s[84:87], s17 offen sc1
    buffer_load_dwordx4 a[172:175], v16, s[84:87], s17 offen sc1
    v_cvt_pk_bf16_f32 v223, v70, v71
    v_cvt_pk_bf16_f32 v231, v194, v195
    v_cvt_pk_bf16_f32 v224, v72, v73
    v_cvt_pk_bf16_f32 v232, v196, v197
    v_cvt_pk_bf16_f32 v225, v74, v75
    v_cvt_pk_bf16_f32 v233, v198, v199
    v_cvt_pk_bf16_f32 v226, v76, v77
    v_cvt_pk_bf16_f32 v234, v200, v201
    v_cvt_pk_bf16_f32 v227, v78, v79
    v_cvt_pk_bf16_f32 v235, v202, v203
    ds_write_b64 v43, v[220:221] offset:32768
    ds_write_b64 v43, v[222:223] offset:32784
    v_mfma_f32_32x32x16_bf16 a[208:223], a[24:27], a[100:103], a[208:223]
    ds_write_b64 v43, v[228:229] offset:32800
    ds_write_b64 v43, v[230:231] offset:32816
    ds_write_b64 v43, v[224:225] offset:32832
    ds_write_b64 v43, v[226:227] offset:32848
    ds_write_b64 v43, v[232:233] offset:32864
    ds_write_b64 v43, v[234:235] offset:32880
    ds_read_b64_tr_b16 v[236:237], v46 offset:37120
    ds_read_b64_tr_b16 v[238:239], v46 offset:37696
    ds_read_b64_tr_b16 v[160:161], v45 offset:32768
    ds_read_b64_tr_b16 v[162:163], v45 offset:33856
    ds_read_b64_tr_b16 v[168:169], v45 offset:32832
    ds_read_b64_tr_b16 v[170:171], v45 offset:33920
    ds_read_b64_tr_b16 v[240:241], v46 offset:38272
    v_mfma_f32_32x32x16_bf16 a[224:239], a[28:31], a[96:99], a[224:239]
    ds_read_b64_tr_b16 v[242:243], v46 offset:38848
    ds_read_b64_tr_b16 v[164:165], v45 offset:34944
    ds_read_b64_tr_b16 v[166:167], v45 offset:36032
    ds_read_b64_tr_b16 v[172:173], v45 offset:35008
    ds_read_b64_tr_b16 v[174:175], v45 offset:36096
    v_cvt_pk_bf16_f32 v180, v112, v113
    v_cvt_pk_bf16_f32 v181, v114, v115
    v_cvt_pk_bf16_f32 v182, v116, v117
    v_cvt_pk_bf16_f32 v183, v118, v119
    v_cvt_pk_bf16_f32 v184, v120, v121
    v_cvt_pk_bf16_f32 v185, v122, v123
    v_cvt_pk_bf16_f32 v186, v124, v125
    v_cvt_pk_bf16_f32 v187, v126, v127
    s_add_u32 m0, s20, 6144
    s_add_u32 s16, s26, 630784
    buffer_load_dwordx4 v11, s[60:63], s16 offen lds
    buffer_load_dwordx4 v12, s[60:63], s16 offen offset:1024 lds
    s_waitcnt lgkmcnt(0)
    v_cndmask_b32 v244, v236, v48, s[98:99]
    v_cndmask_b32 v248, v48, v236, s[98:99]
    v_cndmask_b32 v245, v237, v48, s[98:99]
    v_cndmask_b32 v249, v48, v237, s[98:99]
    v_cndmask_b32 v246, v238, v48, s[98:99]
    v_cndmask_b32 v250, v48, v238, s[98:99]
    v_cndmask_b32 v247, v239, v48, s[98:99]
    v_mfma_f32_32x32x16_bf16 a[240:255], a[28:31], a[100:103], a[240:255]
    v_cndmask_b32 v251, v48, v239, s[98:99]
    v_mfma_f32_32x32x16_bf16 v[128:143], v[160:163], v[244:247], 0
    s_nop 0
    v_mfma_f32_32x32x16_bf16 v[144:159], v[168:171], v[248:251], 0
    s_waitcnt vmcnt(18)
    v_mfma_f32_32x32x16_bf16 a[192:207], a[32:35], a[112:115], a[192:207]
    v_cndmask_b32 v244, v240, v48, s[98:99]
    v_cndmask_b32 v248, v48, v240, s[98:99]
    v_cndmask_b32 v245, v241, v48, s[98:99]
    v_cndmask_b32 v249, v48, v241, s[98:99]
    v_cndmask_b32 v246, v242, v48, s[98:99]
    v_cndmask_b32 v250, v48, v242, s[98:99]
    v_cndmask_b32 v247, v243, v48, s[98:99]
    v_cndmask_b32 v251, v48, v243, s[98:99]
    s_nop 0
    v_mfma_f32_32x32x16_bf16 v[128:143], v[164:167], v[244:247], v[128:143]
    s_add_u32 s17, s25, 24576
    buffer_load_dwordx4 a[176:179], v15, s[84:87], s17 offen sc1
    buffer_load_dwordx4 a[180:183], v16, s[84:87], s17 offen sc1
    v_mfma_f32_32x32x16_bf16 v[144:159], v[172:175], v[248:251], v[144:159]
    ds_write_b64 v44, v[180:181] offset:37120
    ds_write_b64 v44, v[182:183] offset:37136
    ds_write_b64 v44, v[184:185] offset:37152
    ds_write_b64 v44, v[186:187] offset:37168
    v_cvt_pk_bf16_f32 v204, v80, v81
    v_cvt_pk_bf16_f32 v205, v82, v83
    v_cvt_pk_bf16_f32 v206, v84, v85
    v_cvt_pk_bf16_f32 v207, v86, v87
    v_cvt_pk_bf16_f32 v208, v88, v89
    v_cvt_pk_bf16_f32 v209, v90, v91
    v_cvt_pk_bf16_f32 v210, v92, v93
    v_mfma_f32_32x32x16_bf16 a[208:223], a[32:35], a[116:119], a[208:223]
    v_cvt_pk_bf16_f32 v211, v94, v95
    v_lshlrev_b32 v80, 16, v204
    v_and_b32 v81, 0xffff0000, v204
    v_lshlrev_b32 v82, 16, v205
    v_and_b32 v83, 0xffff0000, v205
    v_lshlrev_b32 v84, 16, v206
    v_and_b32 v85, 0xffff0000, v206
    v_lshlrev_b32 v86, 16, v207
    v_and_b32 v87, 0xffff0000, v207
    v_lshlrev_b32 v88, 16, v208
    v_and_b32 v89, 0xffff0000, v208
    v_lshlrev_b32 v90, 16, v209
    v_and_b32 v91, 0xffff0000, v209
    v_mfma_f32_32x32x16_bf16 a[224:239], a[36:39], a[112:115], a[224:239]
    v_lshlrev_b32 v92, 16, v210
    v_and_b32 v93, 0xffff0000, v210
    v_lshlrev_b32 v94, 16, v211
    v_and_b32 v95, 0xffff0000, v211
    v_max3_f32 v204, v80, v81, v82
    v_min3_f32 v208, v80, v81, v82
    v_max3_f32 v206, v88, v89, v90
    v_min3_f32 v210, v88, v89, v90
    v_max3_f32 v204, v204, v83, v84
    v_min3_f32 v208, v208, v83, v84
    v_max3_f32 v206, v206, v91, v92
    v_min3_f32 v210, v210, v91, v92
    v_max3_f32 v204, v204, v85, v86
    s_add_u32 m0, s20, 8192
    s_add_u32 s16, s26, 688128
    buffer_load_dwordx4 v11, s[60:63], s16 offen lds
    buffer_load_dwordx4 v12, s[60:63], s16 offen offset:1024 lds
    s_waitcnt vmcnt(8)
    ds_read_b64_tr_b16 a[184:185], v13 offset:4096
    ds_read_b64_tr_b16 a[186:187], v13 offset:4608
    ds_read_b64_tr_b16 a[188:189], v14 offset:4096
    ds_read_b64_tr_b16 a[190:191], v14 offset:4608
    v_min3_f32 v208, v208, v85, v86
    v_max3_f32 v206, v206, v93, v94
    v_min3_f32 v210, v210, v93, v94
    v_max_f32 v204, v204, v87
    v_min_f32 v208, v208, v87
    v_max_f32 v206, v206, v95
    v_mfma_f32_32x32x16_bf16 a[240:255], a[36:39], a[116:119], a[240:255]
    v_min_f32 v210, v210, v95
    v_permlane32_swap_b32 v204, v206
    s_nop 0
    v_permlane32_swap_b32 v208, v210
    v_max_f32 v204, v204, v206
    v_min_f32 v208, v208, v210
    v_mul_f32 v204, s94, v204
    v_mul_f32 v208, s94, v208
    v_mov_b32 v206, v204
    v_mov_b32 v210, v208
    s_nop 0
    v_permlane32_swap_b32 v204, v206
    v_mfma_f32_32x32x16_bf16 a[192:207], a[40:43], a[120:123], a[192:207]
    v_permlane32_swap_b32 v208, v210
    v_pk_fma_f32 v[188:189], v[80:81], s[94:95], v[208:209] op_sel_hi:[1,1,0] neg_lo:[1,0,0] neg_hi:[1,0,0]
    v_pk_fma_f32 v[80:81], v[80:81], s[94:95], v[204:205] op_sel_hi:[1,1,0] neg_lo:[0,0,1] neg_hi:[0,0,1]
    v_pk_fma_f32 v[190:191], v[82:83], s[94:95], v[208:209] op_sel_hi:[1,1,0] neg_lo:[1,0,0] neg_hi:[1,0,0]
    v_pk_fma_f32 v[82:83], v[82:83], s[94:95], v[204:205] op_sel_hi:[1,1,0] neg_lo:[0,0,1] neg_hi:[0,0,1]
    v_pk_fma_f32 v[192:193], v[84:85], s[94:95], v[208:209] op_sel_hi:[1,1,0] neg_lo:[1,0,0] neg_hi:[1,0,0]
    v_pk_fma_f32 v[84:85], v[84:85], s[94:95], v[204:205] op_sel_hi:[1,1,0] neg_lo:[0,0,1] neg_hi:[0,0,1]
    v_pk_fma_f32 v[194:195], v[86:87], s[94:95], v[208:209] op_sel_hi:[1,1,0] neg_lo:[1,0,0] neg_hi:[1,0,0]
    v_pk_fma_f32 v[86:87], v[86:87], s[94:95], v[204:205] op_sel_hi:[1,1,0] neg_lo:[0,0,1] neg_hi:[0,0,1]
    v_pk_fma_f32 v[196:197], v[88:89], s[94:95], v[210:211] op_sel_hi:[1,1,0] neg_lo:[1,0,0] neg_hi:[1,0,0]
    v_pk_fma_f32 v[88:89], v[88:89], s[94:95], v[206:207] op_sel_hi:[1,1,0] neg_lo:[0,0,1] neg_hi:[0,0,1]
    v_pk_fma_f32 v[198:199], v[90:91], s[94:95], v[210:211] op_sel_hi:[1,1,0] neg_lo:[1,0,0] neg_hi:[1,0,0]
    s_add_u32 s17, s25, 26624
    buffer_load_dwordx4 a[0:3], v15, s[84:87], s17 offen sc1
    buffer_load_dwordx4 a[4:7], v16, s[84:87], s17 offen sc1
    v_pk_fma_f32 v[90:91], v[90:91], s[94:95], v[206:207] op_sel_hi:[1,1,0] neg_lo:[0,0,1] neg_hi:[0,0,1]
    v_pk_fma_f32 v[200:201], v[92:93], s[94:95], v[210:211] op_sel_hi:[1,1,0] neg_lo:[1,0,0] neg_hi:[1,0,0]
    v_pk_fma_f32 v[92:93], v[92:93], s[94:95], v[206:207] op_sel_hi:[1,1,0] neg_lo:[0,0,1] neg_hi:[0,0,1]
    v_pk_fma_f32 v[202:203], v[94:95], s[94:95], v[210:211] op_sel_hi:[1,1,0] neg_lo:[1,0,0] neg_hi:[1,0,0]
    v_pk_fma_f32 v[94:95], v[94:95], s[94:95], v[206:207] op_sel_hi:[1,1,0] neg_lo:[0,0,1] neg_hi:[0,0,1]
    v_exp_f32 v188, v188
    v_exp_f32 v80, v80
    v_exp_f32 v189, v189
    v_exp_f32 v81, v81
    v_mfma_f32_32x32x16_bf16 a[208:223], a[40:43], a[124:127], a[208:223]
    v_exp_f32 v190, v190
    v_exp_f32 v82, v82
    v_exp_f32 v191, v191
    v_exp_f32 v83, v83
    v_exp_f32 v192, v192
    v_exp_f32 v84, v84
    v_mfma_f32_32x32x16_bf16 a[224:239], a[44:47], a[120:123], a[224:239]
    v_exp_f32 v193, v193
    v_exp_f32 v85, v85
    v_exp_f32 v194, v194
    v_exp_f32 v86, v86
    v_exp_f32 v195, v195
    v_exp_f32 v87, v87
    v_exp_f32 v196, v196
    s_add_u32 m0, s20, 16384
    s_add_u32 s16, s26, 745472
    buffer_load_dwordx4 v11, s[60:63], s16 offen lds
    buffer_load_dwordx4 v12, s[60:63], s16 offen offset:1024 lds
    s_waitcnt vmcnt(8)
    ds_read_b64_tr_b16 a[48:49], v13 offset:6144
    ds_read_b64_tr_b16 a[50:51], v13 offset:6656
    ds_read_b64_tr_b16 a[52:53], v14 offset:6144
    ds_read_b64_tr_b16 a[54:55], v14 offset:6656
    v_exp_f32 v88, v88
    v_exp_f32 v197, v197
    v_exp_f32 v89, v89
    v_mfma_f32_32x32x16_bf16 a[240:255], a[44:47], a[124:127], a[240:255]
    v_exp_f32 v198, v198
    v_exp_f32 v90, v90
    v_exp_f32 v199, v199
    v_exp_f32 v91, v91
    v_exp_f32 v200, v200
    v_exp_f32 v92, v92
    v_mfma_f32_32x32x16_bf16 a[192:207], a[56:59], a[128:131], a[192:207]
    v_exp_f32 v201, v201
    v_exp_f32 v93, v93
    v_exp_f32 v202, v202
    v_exp_f32 v94, v94
    v_exp_f32 v203, v203
    v_exp_f32 v95, v95
    v_pk_add_f32 v[204:205], v[80:81], v[82:83]
    s_add_u32 s17, s25, 28672
    buffer_load_dwordx4 a[8:11], v15, s[84:87], s17 offen sc1
    buffer_load_dwordx4 a[12:15], v16, s[84:87], s17 offen sc1
    v_pk_add_f32 v[212:213], v[84:85], v[86:87]
    v_pk_add_f32 v[208:209], v[188:189], v[190:191]
    v_pk_add_f32 v[216:217], v[192:193], v[194:195]
    v_pk_add_f32 v[206:207], v[88:89], v[90:91]
    v_pk_add_f32 v[214:215], v[92:93], v[94:95]
    v_pk_add_f32 v[210:211], v[196:197], v[198:199]
    v_pk_add_f32 v[218:219], v[200:201], v[202:203]
    v_pk_add_f32 v[204:205], v[204:205], v[212:213]
    v_pk_add_f32 v[206:207], v[206:207], v[214:215]
    v_pk_add_f32 v[208:209], v[208:209], v[216:217]
    v_pk_add_f32 v[210:211], v[210:211], v[218:219]
    v_add_f32 v204, v204, v205
    s_nop 0
    v_mfma_f32_32x32x16_bf16 a[208:223], a[56:59], a[132:135], a[208:223]
    v_add_f32 v206, v206, v207
    v_add_f32 v208, v208, v209
    v_add_f32 v210, v210, v211
    v_permlane32_swap_b32 v204, v206
    s_nop 0
    v_permlane32_swap_b32 v208, v210
    v_add_f32 v204, v204, v206
    v_add_f32 v208, v208, v210
    v_rcp_f32 v204, v204
    v_rcp_f32 v208, v208
    v_mfma_f32_32x32x16_bf16 a[224:239], a[60:63], a[128:131], a[224:239]
    v_mov_b32 v206, v204
    v_mov_b32 v210, v208
    s_nop 0
    v_permlane32_swap_b32 v204, v206
    v_permlane32_swap_b32 v208, v210
    v_pk_mul_f32 v[80:81], v[80:81], v[204:205] op_sel_hi:[1,0]
    v_pk_mul_f32 v[188:189], v[188:189], v[208:209] op_sel_hi:[1,0]
    v_pk_mul_f32 v[82:83], v[82:83], v[204:205] op_sel_hi:[1,0]
    v_pk_mul_f32 v[190:191], v[190:191], v[208:209] op_sel_hi:[1,0]
    v_pk_mul_f32 v[84:85], v[84:85], v[204:205] op_sel_hi:[1,0]
    v_pk_mul_f32 v[192:193], v[192:193], v[208:209] op_sel_hi:[1,0]
    v_pk_mul_f32 v[86:87], v[86:87], v[204:205] op_sel_hi:[1,0]
    s_add_u32 m0, s20, 18432
    s_add_u32 s16, s26, 802816
    buffer_load_dwordx4 v11, s[60:63], s16 offen lds
    buffer_load_dwordx4 v12, s[60:63], s16 offen offset:1024 lds
    s_waitcnt vmcnt(8)
    ds_read_b64_tr_b16 a[64:65], v13 offset:8192
    ds_read_b64_tr_b16 a[66:67], v13 offset:8704
    ds_read_b64_tr_b16 a[68:69], v14 offset:8192
    ds_read_b64_tr_b16 a[70:71], v14 offset:8704
    v_pk_mul_f32 v[194:195], v[194:195], v[208:209] op_sel_hi:[1,0]
    v_pk_mul_f32 v[88:89], v[88:89], v[206:207] op_sel_hi:[1,0]
    v_pk_mul_f32 v[196:197], v[196:197], v[210:211] op_sel_hi:[1,0]
    v_pk_mul_f32 v[90:91], v[90:91], v[206:207] op_sel_hi:[1,0]
    v_pk_mul_f32 v[198:199], v[198:199], v[210:211] op_sel_hi:[1,0]
    v_pk_mul_f32 v[92:93], v[92:93], v[206:207] op_sel_hi:[1,0]
    s_nop 1
    v_mfma_f32_32x32x16_bf16 a[240:255], a[60:63], a[132:135], a[240:255]
    v_pk_mul_f32 v[200:201], v[200:201], v[210:211] op_sel_hi:[1,0]
    v_pk_mul_f32 v[94:95], v[94:95], v[206:207] op_sel_hi:[1,0]
    v_pk_mul_f32 v[202:203], v[202:203], v[210:211] op_sel_hi:[1,0]
    v_cvt_pk_bf16_f32 v220, v80, v81
    v_cvt_pk_bf16_f32 v228, v188, v189
    v_cvt_pk_bf16_f32 v221, v82, v83
    v_cvt_pk_bf16_f32 v229, v190, v191
    v_cvt_pk_bf16_f32 v222, v84, v85
    v_cvt_pk_bf16_f32 v230, v192, v193
    v_cvt_pk_bf16_f32 v223, v86, v87
    v_cvt_pk_bf16_f32 v231, v194, v195
    v_cvt_pk_bf16_f32 v224, v88, v89
    v_cvt_pk_bf16_f32 v232, v196, v197
    v_mfma_f32_32x32x16_bf16 a[192:207], a[72:75], a[136:139], a[192:207]
    v_cvt_pk_bf16_f32 v225, v90, v91
    v_cvt_pk_bf16_f32 v233, v198, v199
    v_cvt_pk_bf16_f32 v226, v92, v93
    v_cvt_pk_bf16_f32 v234, v200, v201
    v_cvt_pk_bf16_f32 v227, v94, v95
    v_cvt_pk_bf16_f32 v235, v202, v203
    ds_write_b64 v43, v[220:221] offset:32768
    ds_write_b64 v43, v[222:223] offset:32784
    ds_write_b64 v43, v[228:229] offset:32800
    ds_write_b64 v43, v[230:231] offset:32816
    ds_write_b64 v43, v[224:225] offset:32832
    ds_write_b64 v43, v[226:227] offset:32848
    ds_write_b64 v43, v[232:233] offset:32864
    s_add_u32 s17, s25, 30720
    buffer_load_dwordx4 a[16:19], v15, s[84:87], s17 offen sc1
    buffer_load_dwordx4 a[20:23], v16, s[84:87], s17 offen sc1
    ds_write_b64 v43, v[234:235] offset:32880
    ds_read_b64_tr_b16 v[236:237], v46 offset:37120
    ds_read_b64_tr_b16 v[238:239], v46 offset:37696
    ds_read_b64_tr_b16 v[160:161], v45 offset:32768
    ds_read_b64_tr_b16 v[162:163], v45 offset:33856
    ds_read_b64_tr_b16 v[168:169], v45 offset:32832
    ds_read_b64_tr_b16 v[170:171], v45 offset:33920
    ds_read_b64_tr_b16 v[240:241], v46 offset:38272
    ds_read_b64_tr_b16 v[242:243], v46 offset:38848
    ds_read_b64_tr_b16 v[164:165], v45 offset:34944
    ds_read_b64_tr_b16 v[166:167], v45 offset:36032
    ds_read_b64_tr_b16 v[172:173], v45 offset:35008
    v_mfma_f32_32x32x16_bf16 a[208:223], a[72:75], a[140:143], a[208:223]
    ds_read_b64_tr_b16 v[174:175], v45 offset:36096
    s_waitcnt lgkmcnt(0)
    v_cndmask_b32 v244, v236, v48, s[98:99]
    v_cndmask_b32 v248, v48, v236, s[98:99]
    v_cndmask_b32 v245, v237, v48, s[98:99]
    v_cndmask_b32 v249, v48, v237, s[98:99]
    v_cndmask_b32 v246, v238, v48, s[98:99]
    v_cndmask_b32 v250, v48, v238, s[98:99]
    v_cndmask_b32 v247, v239, v48, s[98:99]
    v_cndmask_b32 v251, v48, v239, s[98:99]
    v_mfma_f32_32x32x16_bf16 a[224:239], a[76:79], a[136:139], a[224:239]
    v_mfma_f32_32x32x16_bf16 v[128:143], v[160:163], v[244:247], v[128:143]
    v_mfma_f32_32x32x16_bf16 v[144:159], v[168:171], v[248:251], v[144:159]
    s_add_u32 m0, s20, 20480
    s_add_u32 s16, s26, 860160
    buffer_load_dwordx4 v11, s[60:63], s16 offen lds
    buffer_load_dwordx4 v12, s[60:63], s16 offen offset:1024 lds
    s_waitcnt vmcnt(8)
    ds_read_b64_tr_b16 a[80:81], v13 offset:16384
    ds_read_b64_tr_b16 a[82:83], v13 offset:16896
    ds_read_b64_tr_b16 a[84:85], v14 offset:16384
    ds_read_b64_tr_b16 a[86:87], v14 offset:16896
    v_cndmask_b32 v244, v240, v48, s[98:99]
    v_cndmask_b32 v248, v48, v240, s[98:99]
    v_cndmask_b32 v245, v241, v48, s[98:99]
    v_cndmask_b32 v249, v48, v241, s[98:99]
    v_cndmask_b32 v246, v242, v48, s[98:99]
    v_cndmask_b32 v250, v48, v242, s[98:99]
    v_cndmask_b32 v247, v243, v48, s[98:99]
    v_cndmask_b32 v251, v48, v243, s[98:99]
    s_nop 0
    v_mfma_f32_32x32x16_bf16 v[128:143], v[164:167], v[244:247], v[128:143]
    v_mfma_f32_32x32x16_bf16 a[240:255], a[76:79], a[140:143], a[240:255]
    v_mfma_f32_32x32x16_bf16 v[144:159], v[172:175], v[248:251], v[144:159]
    v_mfma_f32_32x32x16_bf16 a[192:207], a[88:91], a[144:147], a[192:207]
    s_lshl_b32 s5, s12, 1
    s_add_u32 s5, s5, s10
    s_lshl_b32 s6, s11, 1
    s_add_u32 s6, s6, s9
    s_lshl_b32 s7, s5, 6
    s_add_u32 s7, s7, s6
    s_lshl_b32 s7, s7, 12
    s_add_u32 s7, s7, 0x800000
    s_add_u32 s8, s7, 131072
    s_lshl_b32 s5, s5, 5
    s_add_u32 s5, s5, s6
    s_lshl_b32 s5, s5, 7
    s_add_u32 s5, s5, 0xc20000
    buffer_store_dwordx4 v[128:131], v6, s[84:87], s7 offen offset:0 sc1
    buffer_store_dwordx4 v[132:135], v6, s[84:87], s7 offen offset:1024 sc1
    buffer_store_dwordx4 v[136:139], v6, s[84:87], s7 offen offset:2048 sc1
    buffer_store_dwordx4 v[140:143], v6, s[84:87], s7 offen offset:3072 sc1
    buffer_store_dwordx4 v[144:147], v47, s[84:87], s8 offen offset:0 sc1
    buffer_store_dwordx4 v[148:151], v47, s[84:87], s8 offen offset:1024 sc1
    buffer_store_dwordx4 v[152:155], v47, s[84:87], s8 offen offset:2048 sc1
    buffer_store_dwordx4 v[156:159], v47, s[84:87], s8 offen offset:3072 sc1
    s_mov_b64 exec, -1
    v_mfma_f32_32x32x16_bf16 a[208:223], a[88:91], a[148:151], a[208:223]
    v_mfma_f32_32x32x16_bf16 a[224:239], a[92:95], a[144:147], a[224:239]
    v_mfma_f32_32x32x16_bf16 a[240:255], a[92:95], a[148:151], a[240:255]
    s_mov_b32 s36, s5
    s_branch L_p2
L_qepi:
    s_lshl_b32 s6, s11, 1
    s_add_u32 s6, s6, s9
    v_cndmask_b32 v128, v56, 0, s[98:99]
    s_waitcnt vmcnt(10)
    v_mfma_f32_32x32x16_bf16 a[192:207], a[0:3], a[48:51], 0
    v_cndmask_b32 v132, 0, v56, s[98:99]
    v_cndmask_b32 v129, v57, 0, s[98:99]
    v_cndmask_b32 v133, 0, v57, s[98:99]
    v_cndmask_b32 v130, v58, 0, s[98:99]
    v_cndmask_b32 v134, 0, v58, s[98:99]
    v_cndmask_b32 v131, v59, 0, s[98:99]
    s_add_u32 s17, s25, 12288
    buffer_load_dwordx4 a[128:131], v15, s[84:87], s17 offen sc1
    buffer_load_dwordx4 a[132:135], v16, s[84:87], s17 offen sc1
    v_cndmask_b32 v135, 0, v59, s[98:99]
    v_cvt_pk_bf16_f32 v136, v64, v65
    v_cvt_pk_bf16_f32 v137, v66, v67
    v_cvt_pk_bf16_f32 v138, v68, v69
    v_cvt_pk_bf16_f32 v139, v70, v71
    v_cvt_pk_bf16_f32 v140, v72, v73
    v_cvt_pk_bf16_f32 v141, v74, v75
    v_cvt_pk_bf16_f32 v142, v76, v77
    v_mfma_f32_32x32x16_bf16 a[208:223], a[0:3], a[52:55], 0
    v_cvt_pk_bf16_f32 v143, v78, v79
    v_mfma_f32_32x32x16_bf16 v[64:79], v[128:131], v[136:139], 0
    v_mfma_f32_32x32x16_bf16 a[224:239], a[4:7], a[48:51], 0
    v_mfma_f32_32x32x16_bf16 v[64:79], v[132:135], v[140:143], v[64:79]
    v_cvt_pk_bf16_f32 v136, v80, v81
    v_cvt_pk_bf16_f32 v137, v82, v83
    v_cvt_pk_bf16_f32 v138, v84, v85
    v_cvt_pk_bf16_f32 v139, v86, v87
    v_cvt_pk_bf16_f32 v140, v88, v89
    v_cvt_pk_bf16_f32 v141, v90, v91
    v_cvt_pk_bf16_f32 v142, v92, v93
    v_cvt_pk_bf16_f32 v143, v94, v95
    s_add_u32 s17, s25, 14336
    buffer_load_dwordx4 a[136:139], v15, s[84:87], s17 offen sc1
    buffer_load_dwordx4 a[140:143], v16, s[84:87], s17 offen sc1
    v_mfma_f32_32x32x16_bf16 v[80:95], v[128:131], v[136:139], 0
    v_mfma_f32_32x32x16_bf16 a[240:255], a[4:7], a[52:55], 0
    v_mfma_f32_32x32x16_bf16 v[80:95], v[132:135], v[140:143], v[80:95]
    v_cndmask_b32 v128, v60, 0, s[98:99]
    v_cndmask_b32 v132, 0, v60, s[98:99]
    v_cndmask_b32 v129, v61, 0, s[98:99]
    v_cndmask_b32 v133, 0, v61, s[98:99]
    v_cndmask_b32 v130, v62, 0, s[98:99]
    v_cndmask_b32 v134, 0, v62, s[98:99]
    v_cndmask_b32 v131, v63, 0, s[98:99]
    s_waitcnt vmcnt(12)
    v_mfma_f32_32x32x16_bf16 a[192:207], a[8:11], a[64:67], a[192:207]
    v_cndmask_b32 v135, 0, v63, s[98:99]
    v_cvt_pk_bf16_f32 v136, v96, v97
    v_cvt_pk_bf16_f32 v137, v98, v99
    v_cvt_pk_bf16_f32 v138, v100, v101
    v_cvt_pk_bf16_f32 v139, v102, v103
    v_cvt_pk_bf16_f32 v140, v104, v105
    v_cvt_pk_bf16_f32 v141, v106, v107
    v_cvt_pk_bf16_f32 v142, v108, v109
    s_add_u32 s17, s25, 16384
    buffer_load_dwordx4 a[144:147], v15, s[84:87], s17 offen sc1
    buffer_load_dwordx4 a[148:151], v16, s[84:87], s17 offen sc1
    v_cvt_pk_bf16_f32 v143, v110, v111
    v_mfma_f32_32x32x16_bf16 v[96:111], v[128:131], v[136:139], 0
    v_mfma_f32_32x32x16_bf16 a[208:223], a[8:11], a[68:71], a[208:223]
    v_mfma_f32_32x32x16_bf16 v[96:111], v[132:135], v[140:143], v[96:111]
    v_cvt_pk_bf16_f32 v136, v112, v113
    v_cvt_pk_bf16_f32 v137, v114, v115
    v_cvt_pk_bf16_f32 v138, v116, v117
    v_cvt_pk_bf16_f32 v139, v118, v119
    v_cvt_pk_bf16_f32 v140, v120, v121
    v_cvt_pk_bf16_f32 v141, v122, v123
    v_cvt_pk_bf16_f32 v142, v124, v125
    v_mfma_f32_32x32x16_bf16 a[224:239], a[12:15], a[64:67], a[224:239]
    v_cvt_pk_bf16_f32 v143, v126, v127
    v_mfma_f32_32x32x16_bf16 v[112:127], v[128:131], v[136:139], 0
    s_add_u32 s17, s25, 18432
    buffer_load_dwordx4 a[152:155], v15, s[84:87], s17 offen sc1
    buffer_load_dwordx4 a[156:159], v16, s[84:87], s17 offen sc1
    v_mfma_f32_32x32x16_bf16 v[112:127], v[132:135], v[140:143], v[112:127]
    v_cvt_pk_bf16_f32 v160, v64, v65
    v_cvt_pk_bf16_f32 v161, v66, v67
    v_cvt_pk_bf16_f32 v162, v68, v69
    v_cvt_pk_bf16_f32 v163, v70, v71
    v_cvt_pk_bf16_f32 v164, v72, v73
    v_cvt_pk_bf16_f32 v165, v74, v75
    v_cvt_pk_bf16_f32 v166, v76, v77
    v_cvt_pk_bf16_f32 v167, v78, v79
    v_lshlrev_b32 v64, 16, v160
    v_mfma_f32_32x32x16_bf16 a[240:255], a[12:15], a[68:71], a[240:255]
    v_and_b32 v65, 0xffff0000, v160
    v_lshlrev_b32 v66, 16, v161
    v_and_b32 v67, 0xffff0000, v161
    v_lshlrev_b32 v68, 16, v162
    v_and_b32 v69, 0xffff0000, v162
    v_lshlrev_b32 v70, 16, v163
    v_and_b32 v71, 0xffff0000, v163
    v_lshlrev_b32 v72, 16, v164
    v_and_b32 v73, 0xffff0000, v164
    v_lshlrev_b32 v74, 16, v165
    s_waitcnt vmcnt(14)
    v_mfma_f32_32x32x16_bf16 a[192:207], a[16:19], a[80:83], a[192:207]
    v_and_b32 v75, 0xffff0000, v165
    v_lshlrev_b32 v76, 16, v166
    v_and_b32 v77, 0xffff0000, v166
    v_lshlrev_b32 v78, 16, v167
    v_and_b32 v79, 0xffff0000, v167
    v_max3_f32 v160, v64, v65, v66
    v_min3_f32 v164, v64, v65, v66
    v_max3_f32 v162, v72, v73, v74
    s_add_u32 s17, s25, 20480
    buffer_load_dwordx4 a[160:163], v15, s[84:87], s17 offen sc1
    buffer_load_dwordx4 a[164:167], v16, s[84:87], s17 offen sc1
    v_min3_f32 v166, v72, v73, v74
    v_max3_f32 v160, v160, v67, v68
    v_min3_f32 v164, v164, v67, v68
    v_max3_f32 v162, v162, v75, v76
    v_min3_f32 v166, v166, v75, v76
    v_max3_f32 v160, v160, v69, v70
    v_min3_f32 v164, v164, v69, v70
    v_max3_f32 v162, v162, v77, v78
    v_mfma_f32_32x32x16_bf16 a[208:223], a[16:19], a[84:87], a[208:223]
    v_min3_f32 v166, v166, v77, v78
    v_max_f32 v160, v160, v71
    v_min_f32 v164, v164, v71
    v_max_f32 v162, v162, v79
    v_min_f32 v166, v166, v79
    s_nop 0
    v_permlane32_swap_b32 v160, v162
    v_permlane32_swap_b32 v164, v166
    v_mfma_f32_32x32x16_bf16 a[224:239], a[20:23], a[80:83], a[224:239]
    v_max_f32 v160, v160, v162
    v_min_f32 v164, v164, v166
    v_mul_f32 v160, s94, v160
    v_mul_f32 v164, s94, v164
    v_mov_b32 v162, v160
    v_mov_b32 v166, v164
    s_nop 0
    v_permlane32_swap_b32 v160, v162
    v_permlane32_swap_b32 v164, v166
    s_add_u32 m0, s20, 4096
    s_add_u32 s16, s26, 573440
    buffer_load_dwordx4 v11, s[60:63], s16 offen lds
    buffer_load_dwordx4 v12, s[60:63], s16 offen offset:1024 lds
    v_pk_fma_f32 v[144:145], v[64:65], s[94:95], v[164:165] op_sel_hi:[1,1,0] neg_lo:[1,0,0] neg_hi:[1,0,0]
    v_pk_fma_f32 v[64:65], v[64:65], s[94:95], v[160:161] op_sel_hi:[1,1,0] neg_lo:[0,0,1] neg_hi:[0,0,1]
    v_pk_fma_f32 v[146:147], v[66:67], s[94:95], v[164:165] op_sel_hi:[1,1,0] neg_lo:[1,0,0] neg_hi:[1,0,0]
    v_pk_fma_f32 v[66:67], v[66:67], s[94:95], v[160:161] op_sel_hi:[1,1,0] neg_lo:[0,0,1] neg_hi:[0,0,1]
    v_pk_fma_f32 v[148:149], v[68:69], s[94:95], v[164:165] op_sel_hi:[1,1,0] neg_lo:[1,0,0] neg_hi:[1,0,0]
    v_pk_fma_f32 v[68:69], v[68:69], s[94:95], v[160:161] op_sel_hi:[1,1,0] neg_lo:[0,0,1] neg_hi:[0,0,1]
    v_pk_fma_f32 v[150:151], v[70:71], s[94:95], v[164:165] op_sel_hi:[1,1,0] neg_lo:[1,0,0] neg_hi:[1,0,0]
    s_nop 1
    v_mfma_f32_32x32x16_bf16 a[240:255], a[20:23], a[84:87], a[240:255]
    v_pk_fma_f32 v[70:71], v[70:71], s[94:95], v[160:161] op_sel_hi:[1,1,0] neg_lo:[0,0,1] neg_hi:[0,0,1]
    v_pk_fma_f32 v[152:153], v[72:73], s[94:95], v[166:167] op_sel_hi:[1,1,0] neg_lo:[1,0,0] neg_hi:[1,0,0]
    v_pk_fma_f32 v[72:73], v[72:73], s[94:95], v[162:163] op_sel_hi:[1,1,0] neg_lo:[0,0,1] neg_hi:[0,0,1]
    v_pk_fma_f32 v[154:155], v[74:75], s[94:95], v[166:167] op_sel_hi:[1,1,0] neg_lo:[1,0,0] neg_hi:[1,0,0]
    v_pk_fma_f32 v[74:75], v[74:75], s[94:95], v[162:163] op_sel_hi:[1,1,0] neg_lo:[0,0,1] neg_hi:[0,0,1]
    v_pk_fma_f32 v[156:157], v[76:77], s[94:95], v[166:167] op_sel_hi:[1,1,0] neg_lo:[1,0,0] neg_hi:[1,0,0]
    v_pk_fma_f32 v[76:77], v[76:77], s[94:95], v[162:163] op_sel_hi:[1,1,0] neg_lo:[0,0,1] neg_hi:[0,0,1]
    v_pk_fma_f32 v[158:159], v[78:79], s[94:95], v[166:167] op_sel_hi:[1,1,0] neg_lo:[1,0,0] neg_hi:[1,0,0]
    v_pk_fma_f32 v[78:79], v[78:79], s[94:95], v[162:163] op_sel_hi:[1,1,0] neg_lo:[0,0,1] neg_hi:[0,0,1]
    s_waitcnt vmcnt(16)
    s_nop 0
    v_mfma_f32_32x32x16_bf16 a[192:207], a[24:27], a[96:99], a[192:207]
    v_exp_f32 v144, v144
    v_exp_f32 v64, v64
    v_exp_f32 v145, v145
    v_exp_f32 v65, v65
    s_add_u32 s17, s25, 22528
    buffer_load_dwordx4 a[168:171], v15, s[84:87], s17 offen sc1
    buffer_load_dwordx4 a[172:175], v16, s[84:87], s17 offen sc1
    v_exp_f32 v146, v146
    v_exp_f32 v66, v66
    v_exp_f32 v147, v147
    v_exp_f32 v67, v67
    v_exp_f32 v148, v148
    v_mfma_f32_32x32x16_bf16 a[208:223], a[24:27], a[100:103], a[208:223]
    v_exp_f32 v68, v68
    v_exp_f32 v149, v149
    v_exp_f32 v69, v69
    v_exp_f32 v150, v150
    v_mfma_f32_32x32x16_bf16 a[224:239], a[28:31], a[96:99], a[224:239]
    v_exp_f32 v70, v70
    v_exp_f32 v151, v151
    v_exp_f32 v71, v71
    v_exp_f32 v152, v152
    v_exp_f32 v72, v72
    s_add_u32 m0, s20, 6144
    s_add_u32 s16, s26, 630784
    buffer_load_dwordx4 v11, s[60:63], s16 offen lds
    buffer_load_dwordx4 v12, s[60:63], s16 offen offset:1024 lds
    v_exp_f32 v153, v153
    v_exp_f32 v73, v73
    v_exp_f32 v154, v154
    v_mfma_f32_32x32x16_bf16 a[240:255], a[28:31], a[100:103], a[240:255]
    v_exp_f32 v74, v74
    v_exp_f32 v155, v155
    v_exp_f32 v75, v75
    v_exp_f32 v156, v156
    v_exp_f32 v76, v76
    s_waitcnt vmcnt(18)
    v_mfma_f32_32x32x16_bf16 a[192:207], a[32:35], a[112:115], a[192:207]
    v_exp_f32 v157, v157
    v_exp_f32 v77, v77
    v_exp_f32 v158, v158
    v_exp_f32 v78, v78
    s_add_u32 s17, s25, 24576
    buffer_load_dwordx4 a[176:179], v15, s[84:87], s17 offen sc1
    buffer_load_dwordx4 a[180:183], v16, s[84:87], s17 offen sc1
    v_exp_f32 v159, v159
    v_exp_f32 v79, v79
    v_cvt_pk_bf16_f32 v188, v64, v65
    v_cvt_pk_bf16_f32 v192, v144, v145
    v_cvt_pk_bf16_f32 v189, v66, v67
    v_cvt_pk_bf16_f32 v193, v146, v147
    v_mfma_f32_32x32x16_bf16 a[208:223], a[32:35], a[116:119], a[208:223]
    v_cvt_pk_bf16_f32 v190, v68, v69
    v_cvt_pk_bf16_f32 v194, v148, v149
    v_cvt_pk_bf16_f32 v191, v70, v71
    v_cvt_pk_bf16_f32 v195, v150, v151
    v_cvt_pk_bf16_f32 v196, v72, v73
    v_cvt_pk_bf16_f32 v200, v152, v153
    v_cvt_pk_bf16_f32 v197, v74, v75
    v_cvt_pk_bf16_f32 v201, v154, v155
    v_cvt_pk_bf16_f32 v198, v76, v77
    v_mfma_f32_32x32x16_bf16 a[224:239], a[36:39], a[112:115], a[224:239]
    v_cvt_pk_bf16_f32 v202, v156, v157
    v_cvt_pk_bf16_f32 v199, v78, v79
    v_cvt_pk_bf16_f32 v203, v158, v159
    v_cvt_pk_bf16_f32 v160, v80, v81
    v_cvt_pk_bf16_f32 v161, v82, v83
    v_cvt_pk_bf16_f32 v162, v84, v85
    v_cvt_pk_bf16_f32 v163, v86, v87
    v_cvt_pk_bf16_f32 v164, v88, v89
    v_cvt_pk_bf16_f32 v165, v90, v91
    v_cvt_pk_bf16_f32 v166, v92, v93
    s_add_u32 m0, s20, 8192
    s_add_u32 s16, s26, 688128
    buffer_load_dwordx4 v11, s[60:63], s16 offen lds
    buffer_load_dwordx4 v12, s[60:63], s16 offen offset:1024 lds
    v_cvt_pk_bf16_f32 v167, v94, v95
    v_lshlrev_b32 v80, 16, v160
    v_and_b32 v81, 0xffff0000, v160
    v_lshlrev_b32 v82, 16, v161
    v_and_b32 v83, 0xffff0000, v161
    v_lshlrev_b32 v84, 16, v162
    v_and_b32 v85, 0xffff0000, v162
    s_waitcnt vmcnt(8)
    ds_read_b64_tr_b16 a[184:185], v13 offset:4096
    ds_read_b64_tr_b16 a[186:187], v13 offset:4608
    ds_read_b64_tr_b16 a[188:189], v14 offset:4096
    ds_read_b64_tr_b16 a[190:191], v14 offset:4608
    v_lshlrev_b32 v86, 16, v163
    v_and_b32 v87, 0xffff0000, v163
    v_lshlrev_b32 v88, 16, v164
    v_and_b32 v89, 0xffff0000, v164
    v_lshlrev_b32 v90, 16, v165
    v_and_b32 v91, 0xffff0000, v165
    v_mfma_f32_32x32x16_bf16 a[240:255], a[36:39], a[116:119], a[240:255]
    v_lshlrev_b32 v92, 16, v166
    v_and_b32 v93, 0xffff0000, v166
    v_lshlrev_b32 v94, 16, v167
    v_and_b32 v95, 0xffff0000, v167
    v_max3_f32 v160, v80, v81, v82
    v_min3_f32 v164, v80, v81, v82
    v_max3_f32 v162, v88, v89, v90
    v_min3_f32 v166, v88, v89, v90
    v_max3_f32 v160, v160, v83, v84
    v_mfma_f32_32x32x16_bf16 a[192:207], a[40:43], a[120:123], a[192:207]
    v_min3_f32 v164, v164, v83, v84
    v_max3_f32 v162, v162, v91, v92
    v_min3_f32 v166, v166, v91, v92
    v_max3_f32 v160, v160, v85, v86
    v_min3_f32 v164, v164, v85, v86
    v_max3_f32 v162, v162, v93, v94
    v_min3_f32 v166, v166, v93, v94
    v_max_f32 v160, v160, v87
    v_min_f32 v164, v164, v87
    v_max_f32 v162, v162, v95
    s_add_u32 s17, s25, 26624
    buffer_load_dwordx4 a[0:3], v15, s[84:87], s17 offen sc1
    buffer_load_dwordx4 a[4:7], v16, s[84:87], s17 offen sc1
    v_min_f32 v166, v166, v95
    v_permlane32_swap_b32 v160, v162
    s_nop 0
    v_permlane32_swap_b32 v164, v166
    v_max_f32 v160, v160, v162
    v_min_f32 v164, v164, v166
    v_mul_f32 v160, s94, v160
    v_mfma_f32_32x32x16_bf16 a[208:223], a[40:43], a[124:127], a[208:223]
    v_mul_f32 v164, s94, v164
    v_mov_b32 v162, v160
    v_mov_b32 v166, v164
    s_nop 0
    v_permlane32_swap_b32 v160, v162
    v_permlane32_swap_b32 v164, v166
    v_pk_fma_f32 v[144:145], v[80:81], s[94:95], v[164:165] op_sel_hi:[1,1,0] neg_lo:[1,0,0] neg_hi:[1,0,0]
    v_pk_fma_f32 v[80:81], v[80:81], s[94:95], v[160:161] op_sel_hi:[1,1,0] neg_lo:[0,0,1] neg_hi:[0,0,1]
    s_nop 1
    v_mfma_f32_32x32x16_bf16 a[224:239], a[44:47], a[120:123], a[224:239]
    v_pk_fma_f32 v[146:147], v[82:83], s[94:95], v[164:165] op_sel_hi:[1,1,0] neg_lo:[1,0,0] neg_hi:[1,0,0]
    v_pk_fma_f32 v[82:83], v[82:83], s[94:95], v[160:161] op_sel_hi:[1,1,0] neg_lo:[0,0,1] neg_hi:[0,0,1]
    v_pk_fma_f32 v[148:149], v[84:85], s[94:95], v[164:165] op_sel_hi:[1,1,0] neg_lo:[1,0,0] neg_hi:[1,0,0]
    v_pk_fma_f32 v[84:85], v[84:85], s[94:95], v[160:161] op_sel_hi:[1,1,0] neg_lo:[0,0,1] neg_hi:[0,0,1]
    v_pk_fma_f32 v[150:151], v[86:87], s[94:95], v[164:165] op_sel_hi:[1,1,0] neg_lo:[1,0,0] neg_hi:[1,0,0]
    v_pk_fma_f32 v[86:87], v[86:87], s[94:95], v[160:161] op_sel_hi:[1,1,0] neg_lo:[0,0,1] neg_hi:[0,0,1]
    v_pk_fma_f32 v[152:153], v[88:89], s[94:95], v[166:167] op_sel_hi:[1,1,0] neg_lo:[1,0,0] neg_hi:[1,0,0]
    v_pk_fma_f32 v[88:89], v[88:89], s[94:95], v[162:163] op_sel_hi:[1,1,0] neg_lo:[0,0,1] neg_hi:[0,0,1]
    v_pk_fma_f32 v[154:155], v[90:91], s[94:95], v[166:167] op_sel_hi:[1,1,0] neg_lo:[1,0,0] neg_hi:[1,0,0]
    s_add_u32 m0, s20, 16384
    s_add_u32 s16, s26, 745472
    buffer_load_dwordx4 v11, s[60:63], s16 offen lds
    buffer_load_dwordx4 v12, s[60:63], s16 offen offset:1024 lds
    v_pk_fma_f32 v[90:91], v[90:91], s[94:95], v[162:163] op_sel_hi:[1,1,0] neg_lo:[0,0,1] neg_hi:[0,0,1]
    v_pk_fma_f32 v[156:157], v[92:93], s[94:95], v[166:167] op_sel_hi:[1,1,0] neg_lo:[1,0,0] neg_hi:[1,0,0]
    v_pk_fma_f32 v[92:93], v[92:93], s[94:95], v[162:163] op_sel_hi:[1,1,0] neg_lo:[0,0,1] neg_hi:[0,0,1]
    v_pk_fma_f32 v[158:159], v[94:95], s[94:95], v[166:167] op_sel_hi:[1,1,0] neg_lo:[1,0,0] neg_hi:[1,0,0]
    v_pk_fma_f32 v[94:95], v[94:95], s[94:95], v[162:163] op_sel_hi:[1,1,0] neg_lo:[0,0,1] neg_hi:[0,0,1]
    v_exp_f32 v144, v144
    v_exp_f32 v80, v80
    s_waitcnt vmcnt(8)
    ds_read_b64_tr_b16 a[48:49], v13 offset:6144
    ds_read_b64_tr_b16 a[50:51], v13 offset:6656
    ds_read_b64_tr_b16 a[52:53], v14 offset:6144
    ds_read_b64_tr_b16 a[54:55], v14 offset:6656
    v_exp_f32 v145, v145
    v_exp_f32 v81, v81
    v_exp_f32 v146, v146
    v_mfma_f32_32x32x16_bf16 a[240:255], a[44:47], a[124:127], a[240:255]
    v_exp_f32 v82, v82
    v_exp_f32 v147, v147
    v_exp_f32 v83, v83
    v_exp_f32 v148, v148
    v_mfma_f32_32x32x16_bf16 a[192:207], a[56:59], a[128:131], a[192:207]
    v_exp_f32 v84, v84
    v_exp_f32 v149, v149
    v_exp_f32 v85, v85
    v_exp_f32 v150, v150
    v_exp_f32 v86, v86
    s_add_u32 s17, s25, 28672
    buffer_load_dwordx4 a[8:11], v15, s[84:87], s17 offen sc1
    buffer_load_dwordx4 a[12:15], v16, s[84:87], s17 offen sc1
    v_exp_f32 v151, v151
    v_exp_f32 v87, v87
    v_exp_f32 v152, v152
    v_exp_f32 v88, v88
    v_mfma_f32_32x32x16_bf16 a[208:223], a[56:59], a[132:135], a[208:223]
    v_exp_f32 v153, v153
    v_exp_f32 v89, v89
    v_exp_f32 v154, v154
    v_exp_f32 v90, v90
    v_exp_f32 v155, v155
    v_mfma_f32_32x32x16_bf16 a[224:239], a[60:63], a[128:131], a[224:239]
    v_exp_f32 v91, v91
    v_exp_f32 v156, v156
    v_exp_f32 v92, v92
    v_exp_f32 v157, v157
    s_add_u32 m0, s20, 18432
    s_add_u32 s16, s26, 802816
    buffer_load_dwordx4 v11, s[60:63], s16 offen lds
    buffer_load_dwordx4 v12, s[60:63], s16 offen offset:1024 lds
    v_exp_f32 v93, v93
    v_exp_f32 v158, v158
    v_exp_f32 v94, v94
    v_exp_f32 v159, v159
    s_waitcnt vmcnt(8)
    ds_read_b64_tr_b16 a[64:65], v13 offset:8192
    ds_read_b64_tr_b16 a[66:67], v13 offset:8704
    ds_read_b64_tr_b16 a[68:69], v14 offset:8192
    ds_read_b64_tr_b16 a[70:71], v14 offset:8704
    v_exp_f32 v95, v95
    v_cvt_pk_bf16_f32 v204, v80, v81
    v_cvt_pk_bf16_f32 v208, v144, v145
    v_cvt_pk_bf16_f32 v205, v82, v83
    v_cvt_pk_bf16_f32 v209, v146, v147
    v_mfma_f32_32x32x16_bf16 a[240:255], a[60:63], a[132:135], a[240:255]
    v_cvt_pk_bf16_f32 v206, v84, v85
    v_cvt_pk_bf16_f32 v210, v148, v149
    v_cvt_pk_bf16_f32 v207, v86, v87
    v_cvt_pk_bf16_f32 v211, v150, v151
    v_cvt_pk_bf16_f32 v212, v88, v89
    v_cvt_pk_bf16_f32 v216, v152, v153
    v_cvt_pk_bf16_f32 v213, v90, v91
    v_cvt_pk_bf16_f32 v217, v154, v155
    v_cvt_pk_bf16_f32 v214, v92, v93
    v_mfma_f32_32x32x16_bf16 a[192:207], a[72:75], a[136:139], a[192:207]
    v_cvt_pk_bf16_f32 v218, v156, v157
    v_cvt_pk_bf16_f32 v215, v94, v95
    v_cvt_pk_bf16_f32 v219, v158, v159
    v_cvt_pk_bf16_f32 v160, v96, v97
    v_cvt_pk_bf16_f32 v161, v98, v99
    v_cvt_pk_bf16_f32 v162, v100, v101
    v_cvt_pk_bf16_f32 v163, v102, v103
    v_cvt_pk_bf16_f32 v164, v104, v105
    v_cvt_pk_bf16_f32 v165, v106, v107
    s_add_u32 s17, s25, 30720
    buffer_load_dwordx4 a[16:19], v15, s[84:87], s17 offen sc1
    buffer_load_dwordx4 a[20:23], v16, s[84:87], s17 offen sc1
    v_cvt_pk_bf16_f32 v166, v108, v109
    v_cvt_pk_bf16_f32 v167, v110, v111
    v_lshlrev_b32 v96, 16, v160
    v_and_b32 v97, 0xffff0000, v160
    v_lshlrev_b32 v98, 16, v161
    v_and_b32 v99, 0xffff0000, v161
    v_lshlrev_b32 v100, 16, v162
    v_and_b32 v101, 0xffff0000, v162
    v_mfma_f32_32x32x16_bf16 a[208:223], a[72:75], a[140:143], a[208:223]
    v_lshlrev_b32 v102, 16, v163
    v_and_b32 v103, 0xffff0000, v163
    v_lshlrev_b32 v104, 16, v164
    v_and_b32 v105, 0xffff0000, v164
    v_lshlrev_b32 v106, 16, v165
    v_and_b32 v107, 0xffff0000, v165
    v_lshlrev_b32 v108, 16, v166
    v_and_b32 v109, 0xffff0000, v166
    v_lshlrev_b32 v110, 16, v167
    v_and_b32 v111, 0xffff0000, v167
    v_mfma_f32_32x32x16_bf16 a[224:239], a[76:79], a[136:139], a[224:239]
    v_max3_f32 v160, v96, v97, v98
    v_min3_f32 v164, v96, v97, v98
    v_max3_f32 v162, v104, v105, v106
    v_min3_f32 v166, v104, v105, v106
    v_max3_f32 v160, v160, v99, v100
    v_min3_f32 v164, v164, v99, v100
    v_max3_f32 v162, v162, v107, v108
    v_min3_f32 v166, v166, v107, v108
    v_max3_f32 v160, v160, v101, v102
    s_add_u32 m0, s20, 20480
    s_add_u32 s16, s26, 860160
    buffer_load_dwordx4 v11, s[60:63], s16 offen lds
    buffer_load_dwordx4 v12, s[60:63], s16 offen offset:1024 lds
    v_min3_f32 v164, v164, v101, v102
    v_max3_f32 v162, v162, v109, v110
    v_min3_f32 v166, v166, v109, v110
    v_max_f32 v160, v160, v103
    v_min_f32 v164, v164, v103
    v_max_f32 v162, v162, v111
    v_min_f32 v166, v166, v111
    s_waitcnt vmcnt(8)
    ds_read_b64_tr_b16 a[80:81], v13 offset:16384
    ds_read_b64_tr_b16 a[82:83], v13 offset:16896
    ds_read_b64_tr_b16 a[84:85], v14 offset:16384
    ds_read_b64_tr_b16 a[86:87], v14 offset:16896
    v_permlane32_swap_b32 v160, v162
    v_permlane32_swap_b32 v164, v166
    v_max_f32 v160, v160, v162
    v_min_f32 v164, v164, v166
    v_mfma_f32_32x32x16_bf16 a[240:255], a[76:79], a[140:143], a[240:255]
    v_mul_f32 v160, s94, v160
    v_mul_f32 v164, s94, v164
    v_mov_b32 v162, v160
    v_mov_b32 v166, v164
    s_nop 0
    v_permlane32_swap_b32 v160, v162
    v_permlane32_swap_b32 v164, v166
    v_pk_fma_f32 v[144:145], v[96:97], s[94:95], v[164:165] op_sel_hi:[1,1,0] neg_lo:[1,0,0] neg_hi:[1,0,0]
    v_pk_fma_f32 v[96:97], v[96:97], s[94:95], v[160:161] op_sel_hi:[1,1,0] neg_lo:[0,0,1] neg_hi:[0,0,1]
    s_waitcnt lgkmcnt(15)
    s_nop 0
    v_mfma_f32_32x32x16_bf16 a[192:207], a[88:91], a[144:147], a[192:207]
    v_pk_fma_f32 v[146:147], v[98:99], s[94:95], v[164:165] op_sel_hi:[1,1,0] neg_lo:[1,0,0] neg_hi:[1,0,0]
    v_pk_fma_f32 v[98:99], v[98:99], s[94:95], v[160:161] op_sel_hi:[1,1,0] neg_lo:[0,0,1] neg_hi:[0,0,1]
    v_pk_fma_f32 v[148:149], v[100:101], s[94:95], v[164:165] op_sel_hi:[1,1,0] neg_lo:[1,0,0] neg_hi:[1,0,0]
    v_pk_fma_f32 v[100:101], v[100:101], s[94:95], v[160:161] op_sel_hi:[1,1,0] neg_lo:[0,0,1] neg_hi:[0,0,1]
    v_pk_fma_f32 v[150:151], v[102:103], s[94:95], v[164:165] op_sel_hi:[1,1,0] neg_lo:[1,0,0] neg_hi:[1,0,0]
    s_nop 1
    v_mfma_f32_32x32x16_bf16 a[208:223], a[88:91], a[148:151], a[208:223]
    v_pk_fma_f32 v[102:103], v[102:103], s[94:95], v[160:161] op_sel_hi:[1,1,0] neg_lo:[0,0,1] neg_hi:[0,0,1]
    v_pk_fma_f32 v[152:153], v[104:105], s[94:95], v[166:167] op_sel_hi:[1,1,0] neg_lo:[1,0,0] neg_hi:[1,0,0]
    v_pk_fma_f32 v[104:105], v[104:105], s[94:95], v[162:163] op_sel_hi:[1,1,0] neg_lo:[0,0,1] neg_hi:[0,0,1]
    v_pk_fma_f32 v[154:155], v[106:107], s[94:95], v[166:167] op_sel_hi:[1,1,0] neg_lo:[1,0,0] neg_hi:[1,0,0]
    v_pk_fma_f32 v[106:107], v[106:107], s[94:95], v[162:163] op_sel_hi:[1,1,0] neg_lo:[0,0,1] neg_hi:[0,0,1]
    v_pk_fma_f32 v[156:157], v[108:109], s[94:95], v[166:167] op_sel_hi:[1,1,0] neg_lo:[1,0,0] neg_hi:[1,0,0]
    v_pk_fma_f32 v[108:109], v[108:109], s[94:95], v[162:163] op_sel_hi:[1,1,0] neg_lo:[0,0,1] neg_hi:[0,0,1]
    v_pk_fma_f32 v[158:159], v[110:111], s[94:95], v[166:167] op_sel_hi:[1,1,0] neg_lo:[1,0,0] neg_hi:[1,0,0]
    v_pk_fma_f32 v[110:111], v[110:111], s[94:95], v[162:163] op_sel_hi:[1,1,0] neg_lo:[0,0,1] neg_hi:[0,0,1]
    s_nop 1
    v_mfma_f32_32x32x16_bf16 a[224:239], a[92:95], a[144:147], a[224:239]
    v_exp_f32 v144, v144
    v_exp_f32 v96, v96
    v_exp_f32 v145, v145
    v_exp_f32 v97, v97
    v_exp_f32 v146, v146
    v_mfma_f32_32x32x16_bf16 a[240:255], a[92:95], a[148:151], a[240:255]
    v_exp_f32 v98, v98
    v_exp_f32 v147, v147
    v_exp_f32 v99, v99
    v_exp_f32 v148, v148
    v_exp_f32 v100, v100
    v_exp_f32 v149, v149
    v_exp_f32 v101, v101
    v_exp_f32 v150, v150
    v_exp_f32 v102, v102
    v_exp_f32 v151, v151
    v_exp_f32 v103, v103
    v_exp_f32 v152, v152
    v_exp_f32 v104, v104
    v_exp_f32 v153, v153
    v_exp_f32 v105, v105
    v_exp_f32 v154, v154
    v_exp_f32 v106, v106
    v_exp_f32 v155, v155
    v_exp_f32 v107, v107
    v_exp_f32 v156, v156
    v_exp_f32 v108, v108
    v_exp_f32 v157, v157
    v_exp_f32 v109, v109
    v_exp_f32 v158, v158
    v_exp_f32 v110, v110
    v_exp_f32 v159, v159
    v_exp_f32 v111, v111
    v_cvt_pk_bf16_f32 v220, v96, v97
    v_cvt_pk_bf16_f32 v224, v144, v145
    v_cvt_pk_bf16_f32 v221, v98, v99
    v_cvt_pk_bf16_f32 v225, v146, v147
    v_cvt_pk_bf16_f32 v222, v100, v101
    v_cvt_pk_bf16_f32 v226, v148, v149
    v_cvt_pk_bf16_f32 v223, v102, v103
    v_cvt_pk_bf16_f32 v227, v150, v151
    v_cvt_pk_bf16_f32 v228, v104, v105
    v_cvt_pk_bf16_f32 v232, v152, v153
    v_cvt_pk_bf16_f32 v229, v106, v107
    v_cvt_pk_bf16_f32 v233, v154, v155
    v_cvt_pk_bf16_f32 v230, v108, v109
    v_cvt_pk_bf16_f32 v234, v156, v157
    v_cvt_pk_bf16_f32 v231, v110, v111
    v_cvt_pk_bf16_f32 v235, v158, v159
    v_cvt_pk_bf16_f32 v160, v112, v113
    v_cvt_pk_bf16_f32 v161, v114, v115
    v_cvt_pk_bf16_f32 v162, v116, v117
    v_cvt_pk_bf16_f32 v163, v118, v119
    v_cvt_pk_bf16_f32 v164, v120, v121
    v_cvt_pk_bf16_f32 v165, v122, v123
    v_cvt_pk_bf16_f32 v166, v124, v125
    v_cvt_pk_bf16_f32 v167, v126, v127
    v_lshlrev_b32 v112, 16, v160
    v_and_b32 v113, 0xffff0000, v160
    v_lshlrev_b32 v114, 16, v161
    v_and_b32 v115, 0xffff0000, v161
    v_lshlrev_b32 v116, 16, v162
    v_and_b32 v117, 0xffff0000, v162
    v_lshlrev_b32 v118, 16, v163
    v_and_b32 v119, 0xffff0000, v163
    v_lshlrev_b32 v120, 16, v164
    v_and_b32 v121, 0xffff0000, v164
    v_lshlrev_b32 v122, 16, v165
    v_and_b32 v123, 0xffff0000, v165
    v_lshlrev_b32 v124, 16, v166
    v_and_b32 v125, 0xffff0000, v166
    v_lshlrev_b32 v126, 16, v167
    v_and_b32 v127, 0xffff0000, v167
    v_max3_f32 v160, v112, v113, v114
    v_min3_f32 v164, v112, v113, v114
    v_max3_f32 v162, v120, v121, v122
    v_min3_f32 v166, v120, v121, v122
    v_max3_f32 v160, v160, v115, v116
    v_min3_f32 v164, v164, v115, v116
    v_max3_f32 v162, v162, v123, v124
    v_min3_f32 v166, v166, v123, v124
    v_max3_f32 v160, v160, v117, v118
    v_min3_f32 v164, v164, v117, v118
    v_max3_f32 v162, v162, v125, v126
    v_min3_f32 v166, v166, v125, v126
    v_max_f32 v160, v160, v119
    v_min_f32 v164, v164, v119
    v_max_f32 v162, v162, v127
    v_min_f32 v166, v166, v127
    s_nop 0
    v_permlane32_swap_b32 v160, v162
    v_permlane32_swap_b32 v164, v166
    v_max_f32 v160, v160, v162
    v_min_f32 v164, v164, v166
    v_mul_f32 v160, s94, v160
    v_mul_f32 v164, s94, v164
    v_mov_b32 v162, v160
    v_mov_b32 v166, v164
    s_nop 0
    v_permlane32_swap_b32 v160, v162
    v_permlane32_swap_b32 v164, v166
    v_pk_fma_f32 v[144:145], v[112:113], s[94:95], v[164:165] op_sel_hi:[1,1,0] neg_lo:[1,0,0] neg_hi:[1,0,0]
    v_pk_fma_f32 v[112:113], v[112:113], s[94:95], v[160:161] op_sel_hi:[1,1,0] neg_lo:[0,0,1] neg_hi:[0,0,1]
    v_pk_fma_f32 v[146:147], v[114:115], s[94:95], v[164:165] op_sel_hi:[1,1,0] neg_lo:[1,0,0] neg_hi:[1,0,0]
    v_pk_fma_f32 v[114:115], v[114:115], s[94:95], v[160:161] op_sel_hi:[1,1,0] neg_lo:[0,0,1] neg_hi:[0,0,1]
    v_pk_fma_f32 v[148:149], v[116:117], s[94:95], v[164:165] op_sel_hi:[1,1,0] neg_lo:[1,0,0] neg_hi:[1,0,0]
    v_pk_fma_f32 v[116:117], v[116:117], s[94:95], v[160:161] op_sel_hi:[1,1,0] neg_lo:[0,0,1] neg_hi:[0,0,1]
    v_pk_fma_f32 v[150:151], v[118:119], s[94:95], v[164:165] op_sel_hi:[1,1,0] neg_lo:[1,0,0] neg_hi:[1,0,0]
    v_pk_fma_f32 v[118:119], v[118:119], s[94:95], v[160:161] op_sel_hi:[1,1,0] neg_lo:[0,0,1] neg_hi:[0,0,1]
    v_pk_fma_f32 v[152:153], v[120:121], s[94:95], v[166:167] op_sel_hi:[1,1,0] neg_lo:[1,0,0] neg_hi:[1,0,0]
    v_pk_fma_f32 v[120:121], v[120:121], s[94:95], v[162:163] op_sel_hi:[1,1,0] neg_lo:[0,0,1] neg_hi:[0,0,1]
    v_pk_fma_f32 v[154:155], v[122:123], s[94:95], v[166:167] op_sel_hi:[1,1,0] neg_lo:[1,0,0] neg_hi:[1,0,0]
    v_pk_fma_f32 v[122:123], v[122:123], s[94:95], v[162:163] op_sel_hi:[1,1,0] neg_lo:[0,0,1] neg_hi:[0,0,1]
    v_pk_fma_f32 v[156:157], v[124:125], s[94:95], v[166:167] op_sel_hi:[1,1,0] neg_lo:[1,0,0] neg_hi:[1,0,0]
    v_pk_fma_f32 v[124:125], v[124:125], s[94:95], v[162:163] op_sel_hi:[1,1,0] neg_lo:[0,0,1] neg_hi:[0,0,1]
    v_pk_fma_f32 v[158:159], v[126:127], s[94:95], v[166:167] op_sel_hi:[1,1,0] neg_lo:[1,0,0] neg_hi:[1,0,0]
    v_pk_fma_f32 v[126:127], v[126:127], s[94:95], v[162:163] op_sel_hi:[1,1,0] neg_lo:[0,0,1] neg_hi:[0,0,1]
    v_exp_f32 v144, v144
    v_exp_f32 v112, v112
    v_exp_f32 v145, v145
    v_exp_f32 v113, v113
    v_exp_f32 v146, v146
    v_exp_f32 v114, v114
    v_exp_f32 v147, v147
    v_exp_f32 v115, v115
    v_exp_f32 v148, v148
    v_exp_f32 v116, v116
    v_exp_f32 v149, v149
    v_exp_f32 v117, v117
    v_exp_f32 v150, v150
    v_exp_f32 v118, v118
    v_exp_f32 v151, v151
    v_exp_f32 v119, v119
    v_exp_f32 v152, v152
    v_exp_f32 v120, v120
    v_exp_f32 v153, v153
    v_exp_f32 v121, v121
    v_exp_f32 v154, v154
    v_exp_f32 v122, v122
    v_exp_f32 v155, v155
    v_exp_f32 v123, v123
    v_exp_f32 v156, v156
    v_exp_f32 v124, v124
    v_exp_f32 v157, v157
    v_exp_f32 v125, v125
    v_exp_f32 v158, v158
    v_exp_f32 v126, v126
    v_exp_f32 v159, v159
    v_exp_f32 v127, v127
    v_cvt_pk_bf16_f32 v236, v112, v113
    v_cvt_pk_bf16_f32 v240, v144, v145
    v_cvt_pk_bf16_f32 v237, v114, v115
    v_cvt_pk_bf16_f32 v241, v146, v147
    v_cvt_pk_bf16_f32 v238, v116, v117
    v_cvt_pk_bf16_f32 v242, v148, v149
    v_cvt_pk_bf16_f32 v239, v118, v119
    v_cvt_pk_bf16_f32 v243, v150, v151
    v_cvt_pk_bf16_f32 v244, v120, v121
    v_cvt_pk_bf16_f32 v248, v152, v153
    v_cvt_pk_bf16_f32 v245, v122, v123
    v_cvt_pk_bf16_f32 v249, v154, v155
    v_cvt_pk_bf16_f32 v246, v124, v125
    v_cvt_pk_bf16_f32 v250, v156, v157
    v_cvt_pk_bf16_f32 v247, v126, v127
    v_cvt_pk_bf16_f32 v251, v158, v159
    s_lshl_b32 s5, s12, 1
    s_add_u32 s5, s5, s10
    s_lshl_b32 s5, s5, 5
    s_add_u32 s5, s5, s6
    s_lshl_b32 s5, s5, 7
    s_add_u32 s36, s5, 0xc18000
    s_branch L_p2
L_helper:
    s_mov_b32 s56, s34
    s_mov_b32 s57, s35
    s_mov_b32 s58, 0x400
    s_mov_b32 s59, 0x20000
    s_lshl_b32 s5, s96, 3
    s_add_u32 s5, s5, s97
    s_sub_u32 s5, s5, 24
    s_lshl_b32 s11, s5, 2
    s_add_u32 s11, s11, s3
    s_lshl_b32 s12, s5, 7
    s_lshl_b32 s5, s11, 13
    buffer_load_dwordx4 v[48:51], v6, s[44:47], s5 offen offset:0
    buffer_load_dwordx4 v[52:55], v6, s[44:47], s5 offen offset:1024
    buffer_load_dwordx4 v[56:59], v6, s[44:47], s5 offen offset:2048
    buffer_load_dwordx4 v[60:63], v6, s[44:47], s5 offen offset:3072
    s_add_u32 s5, s5, 4096
    buffer_load_dwordx4 v[64:67], v6, s[44:47], s5 offen offset:0
    buffer_load_dwordx4 v[68:71], v6, s[44:47], s5 offen offset:1024
    buffer_load_dwordx4 v[72:75], v6, s[44:47], s5 offen offset:2048
    buffer_load_dwordx4 v[76:79], v6, s[44:47], s5 offen offset:3072
    buffer_load_dwordx4 v[80:83], v6, s[56:59], 0 offen
    s_mov_b32 s60, s26
    s_mov_b32 s61, s27
    s_mov_b32 s62, 0x700000
    s_mov_b32 s63, 0x20000
    v_mul_u32_u24 v2, 37, v1
    v_lshrrev_b32 v2, 8, v2
    v_mul_u32_u24 v3, 7, v2
    v_sub_u32 v3, v1, v3
    v_min_u32 v2, 7, v2
    v_mul_u32_u24 v46, 3584, v2
    v_lshl_add_u32 v46, v3, 7, v46
    s_bfe_u32 s5, s11, 0x20004
    s_lshl_b32 s5, s5, 6
    s_and_b32 s6, s11, 15
    s_add_u32 s5, s5, s6
    s_mul_i32 s15, s5, 28672
    s_lshr_b32 s5, s96, 1
    s_mul_i32 s5, s5, 896
    s_add_u32 s15, s15, s5
    s_mov_b32 s64, s28
    s_mov_b32 s65, s29
    s_mov_b32 s66, 0xe00
    s_mov_b32 s67, 0x20000
    s_mov_b32 s72, s32
    s_mov_b32 s73, s33
    s_mov_b32 s74, 0x1000
    s_mov_b32 s75, 0x20000
    s_mov_b32 s52, s20
    s_mov_b32 s53, s21
    s_mov_b32 s54, 0x4000
    s_mov_b32 s55, 0x20000
    s_and_b32 s5, s11, 31
    s_lshl_b32 s6, s5, 7
    s_lshl_b32 s5, s5, 9
    s_mov_b64 exec, 0xf
    buffer_load_dword v45, v7, s[52:55], s5 offen
    s_mov_b64 exec, 1
    buffer_load_dword v45, v7, s[64:67], s6 offen
    buffer_load_dword v45, v7, s[72:75], s6 offen
    s_mov_b64 exec, -1
    buffer_load_dword v45, v46, s[60:63], s15 offen
    s_and_b32 s14, s11, 63
    s_lshr_b32 s8, s14, 4
    s_mul_i32 s8, s8, 56
    s_and_b32 s6, s14, 15
    s_add_u32 s8, s8, s6
    s_lshl_b32 s42, s8, 15
    s_lshr_b32 s7, s96, 1
    s_lshl_b32 s5, s7, 10
    s_add_u32 s42, s42, s5
    s_and_b32 s43, s11, 31
    s_lshl_b32 s43, s43, 14
    s_and_b32 s5, s96, 1
    s_lshl_b32 s5, s5, 9
    s_add_u32 s43, s43, s5
    v_lshrrev_b32 v2, 3, v1
    v_and_b32 v3, 7, v1
    v_lshlrev_b32 v3, 7, v3
    v_lshl_add_u32 v43, v2, 12, v3
    v_lshrrev_b32 v2, 2, v1
    v_and_b32 v3, 3, v1
    v_lshlrev_b32 v3, 7, v3
    v_lshl_add_u32 v44, v2, 10, v3
    s_mov_b32 s84, s40
    s_mov_b32 s85, s41
    s_mov_b32 s86, 0xe00000
    s_mov_b32 s87, 0x20000
    s_mov_b32 s52, s20
    s_mov_b32 s53, s21
    s_mov_b32 s54, 0x4000
    s_mov_b32 s55, 0x20000
    s_mov_b32 s60, s26
    s_mov_b32 s61, s27
    s_mov_b32 s62, 0x700000
    s_mov_b32 s63, 0x20000
    s_mov_b32 s64, s28
    s_mov_b32 s65, s29
    s_mov_b32 s66, 0xe00
    s_mov_b32 s67, 0x20000
    s_mov_b32 s68, s30
    s_mov_b32 s69, s31
    s_mov_b32 s70, 0x700000
    s_mov_b32 s71, 0x20000
    s_mov_b32 s72, s32
    s_mov_b32 s73, s33
    s_mov_b32 s74, 0x1000
    s_mov_b32 s75, 0x20000
    s_mov_b32 s76, s22
    s_mov_b32 s77, s23
    s_mov_b32 s78, 0x80000
    s_mov_b32 s79, 0x20000
    s_mov_b32 s80, s36
    s_mov_b32 s81, s37
    s_mov_b32 s82, 0x200000
    s_mov_b32 s83, 0x20000
    s_mov_b32 s5, 0xc38000
    v_mov_b32 v2, 0
    buffer_load_dword v8, v2, s[84:87], s5 offen sc1
    s_mov_b32 s94, 0x3fb8aa3b
    s_mov_b32 s95, 0x3fb8aa3b
    s_mul_i32 s20, s3, 40960
    s_and_b32 s21, s96, 1
    s_lshl_b32 s21, s21, 2
    s_and_b32 s5, s97, 3
    s_add_u32 s21, s21, s5
    s_lshr_b32 s22, s96, 1
    s_mul_i32 s22, s22, 7
    s_lshr_b32 s6, s97, 2
    s_add_u32 s22, s22, s6
    s_lshl_b32 s23, s21, 2
    s_lshl_b32 s24, s21, 13
    s_lshl_b32 s25, s21, 18
    s_lshl_b32 s7, s3, 16
    s_add_u32 s25, s25, s7
    s_mul_i32 s26, s3, 1835008
    s_lshl_b32 s7, s22, 7
    s_add_u32 s26, s26, s7
    s_lshl_b32 s27, s96, 2
    s_add_u32 s27, s27, s97
    s_sub_u32 s27, s27, 28
    s_and_b32 s28, s97, 7
    s_lshl_b32 s29, s96, 2
    s_lshr_b32 s7, s97, 3
    s_add_u32 s29, s29, s7
    s_mul_i32 s32, s28, 112
    s_mul_i32 s7, s3, 28
    s_add_u32 s32, s32, s7
    s_lshl_b32 s32, s32, 11
    s_add_u32 s32, s32, 0x400000
    s_lshl_b32 s33, s7, 16
    s_lshl_b32 s7, s29, 7
    s_add_u32 s33, s33, s7
    s_lshl_b32 s34, s29, 16
    s_lshl_b32 s7, s3, 14
    s_add_u32 s34, s34, s7
    s_add_u32 s34, s34, 0x600000
    s_lshl_b32 s35, s3, 17
    s_lshl_b32 s7, s28, 7
    s_add_u32 s35, s35, s7
    v_lshrrev_b32 v4, 3, v1
    v_mul_u32_u24 v11, 3584, v4
    v_add_u32 v11, v11, v10
    v_add_u32 v12, 27648, v11
    v_mul_u32_u24 v19, 4096, v4
    v_add_u32 v19, v19, v10
    v_add_u32 v20, 31744, v19
    v_mul_u32_u24 v21, 1024, v4
    v_add_u32 v21, v21, v10
    v_add_u32 v22, 7168, v21
    s_lshl_b32 s5, s9, 6
    s_lshl_b32 s6, s10, 6
    v_bfe_u32 v2, v1, 2, 2
    v_lshrrev_b32 v3, 5, v1
    v_lshl_add_u32 v2, v3, 3, v2
    v_lshlrev_b32 v2, 7, v2
    v_bfe_u32 v3, v1, 4, 1
    v_lshl_add_u32 v2, v3, 5, v2
    v_and_b32 v3, 3, v1
    v_lshl_add_u32 v2, v3, 3, v2
    v_bfe_u32 v3, v1, 3, 1
    v_lshl_add_u32 v13, v3, 6, v2
    v_xor_b32 v13, s6, v13
    v_add_u32 v13, s20, v13
    v_xor_b32 v14, 64, v13
    v_bfe_u32 v2, v1, 2, 2
    v_lshrrev_b32 v3, 5, v1
    v_lshl_add_u32 v2, v3, 2, v2
    v_lshlrev_b32 v2, 7, v2
    v_bfe_u32 v3, v1, 4, 1
    v_lshl_add_u32 v2, v3, 5, v2
    v_and_b32 v3, 3, v1
    v_lshl_add_u32 v2, v3, 3, v2
    v_bfe_u32 v3, v1, 3, 1
    v_lshl_add_u32 v23, v3, 6, v2
    v_add_u32 v23, s20, v23
    v_xor_b32 v25, s6, v23
    v_xor_b32 v23, s5, v23
    v_xor_b32 v24, 64, v23
    v_xor_b32 v26, 64, v25
    s_lshl_b32 s5, s9, 10
    s_lshl_b32 s6, s10, 10
    v_add_u32 v15, s5, v6
    v_add_u32 v17, s6, v6
    v_xor_b32 v16, 0x400, v15
    v_xor_b32 v18, 0x400, v17
    v_add_u32 v27, s20, v6
    v_and_b32 v3, 16, v1
    v_cmp_ne_u32 s[98:99], 0, v3
    v_mov_b32 v152, 0x3f803f80
    v_bfe_u32 v2, v1, 2, 2
    v_mul_u32_u24 v2, 1088, v2
    v_lshrrev_b32 v3, 4, v1
    v_lshlrev_b32 v3, 5, v3
    v_and_b32 v4, 3, v1
    v_lshl_add_u32 v3, v4, 3, v3
    v_add3_u32 v153, v2, v3, s20
    v_lshrrev_b32 v3, 5, v1
    v_and_b32 v4, 31, v1
    v_lshlrev_b32 v4, 4, v4
    v_lshl_add_u32 v154, v3, 10, v4
    v_lshrrev_b32 v155, 1, v1
    s_waitcnt vmcnt(5)
    v_dot2_f32_bf16 v116, v48, v152, 0
    v_dot2_f32_bf16 v117, v52, v152, 0
    v_dot2_f32_bf16 v118, v56, v152, 0
    v_dot2_f32_bf16 v119, v60, v152, 0
    v_dot2_f32_bf16 v120, v64, v152, 0
    v_dot2_f32_bf16 v121, v68, v152, 0
    v_dot2_f32_bf16 v122, v72, v152, 0
    v_dot2_f32_bf16 v123, v76, v152, 0
    v_dot2_f32_bf16 v116, v49, v152, v116
    v_dot2_f32_bf16 v117, v53, v152, v117
    v_dot2_f32_bf16 v118, v57, v152, v118
    v_dot2_f32_bf16 v119, v61, v152, v119
    v_dot2_f32_bf16 v120, v65, v152, v120
    v_dot2_f32_bf16 v121, v69, v152, v121
    v_dot2_f32_bf16 v122, v73, v152, v122
    v_dot2_f32_bf16 v123, v77, v152, v123
    v_dot2_f32_bf16 v116, v50, v152, v116
    v_dot2_f32_bf16 v117, v54, v152, v117
    v_dot2_f32_bf16 v118, v58, v152, v118
    v_dot2_f32_bf16 v119, v62, v152, v119
    v_dot2_f32_bf16 v120, v66, v152, v120
    v_dot2_f32_bf16 v121, v70, v152, v121
    v_dot2_f32_bf16 v122, v74, v152, v122
    v_dot2_f32_bf16 v123, v78, v152, v123
    v_dot2_f32_bf16 v116, v51, v152, v116
    v_dot2_f32_bf16 v117, v55, v152, v117
    v_dot2_f32_bf16 v118, v59, v152, v118
    v_dot2_f32_bf16 v119, v63, v152, v119
    v_dot2_f32_bf16 v120, v67, v152, v120
    v_dot2_f32_bf16 v121, v71, v152, v121
    v_dot2_f32_bf16 v122, v75, v152, v122
    v_dot2_f32_bf16 v123, v79, v152, v123
    v_dot2_f32_bf16 v124, v48, v80, 0
    v_dot2_f32_bf16 v125, v52, v80, 0
    v_dot2_f32_bf16 v126, v56, v80, 0
    v_dot2_f32_bf16 v127, v60, v80, 0
    v_dot2_f32_bf16 v128, v64, v80, 0
    v_dot2_f32_bf16 v129, v68, v80, 0
    v_dot2_f32_bf16 v130, v72, v80, 0
    v_dot2_f32_bf16 v131, v76, v80, 0
    v_dot2_f32_bf16 v124, v49, v81, v124
    v_dot2_f32_bf16 v125, v53, v81, v125
    v_dot2_f32_bf16 v126, v57, v81, v126
    v_dot2_f32_bf16 v127, v61, v81, v127
    v_dot2_f32_bf16 v128, v65, v81, v128
    v_dot2_f32_bf16 v129, v69, v81, v129
    v_dot2_f32_bf16 v130, v73, v81, v130
    v_dot2_f32_bf16 v131, v77, v81, v131
    v_dot2_f32_bf16 v124, v50, v82, v124
    v_dot2_f32_bf16 v125, v54, v82, v125
    v_dot2_f32_bf16 v126, v58, v82, v126
    v_dot2_f32_bf16 v127, v62, v82, v127
    v_dot2_f32_bf16 v128, v66, v82, v128
    v_dot2_f32_bf16 v129, v70, v82, v129
    v_dot2_f32_bf16 v130, v74, v82, v130
    v_dot2_f32_bf16 v131, v78, v82, v131
    v_dot2_f32_bf16 v124, v51, v83, v124
    v_dot2_f32_bf16 v125, v55, v83, v125
    v_dot2_f32_bf16 v126, v59, v83, v126
    v_dot2_f32_bf16 v127, v63, v83, v127
    v_dot2_f32_bf16 v128, v67, v83, v128
    v_dot2_f32_bf16 v129, v71, v83, v129
    v_dot2_f32_bf16 v130, v75, v83, v130
    v_dot2_f32_bf16 v131, v79, v83, v131
    v_permlane32_swap_b32 v116, v120
    v_permlane32_swap_b32 v117, v121
    v_permlane32_swap_b32 v118, v122
    v_permlane32_swap_b32 v119, v123
    v_permlane32_swap_b32 v124, v128
    v_permlane32_swap_b32 v125, v129
    v_permlane32_swap_b32 v126, v130
    v_permlane32_swap_b32 v127, v131
    v_add_f32 v116, v116, v120
    v_add_f32 v117, v117, v121
    v_add_f32 v118, v118, v122
    v_add_f32 v119, v119, v123
    v_add_f32 v124, v124, v128
    v_add_f32 v125, v125, v129
    v_add_f32 v126, v126, v130
    v_add_f32 v127, v127, v131
    v_permlane16_swap_b32 v116, v118
    v_permlane16_swap_b32 v117, v119
    v_permlane16_swap_b32 v124, v126
    v_permlane16_swap_b32 v125, v127
    v_add_f32 v116, v116, v118
    v_add_f32 v117, v117, v119
    v_add_f32 v124, v124, v126
    v_add_f32 v125, v125, v127
    v_add_f32 v116, v116, v116 row_ror:8 row_mask:0xf bank_mask:0xf
    v_add_f32 v117, v117, v117 row_ror:8 row_mask:0xf bank_mask:0xf
    v_add_f32 v124, v124, v124 row_ror:8 row_mask:0xf bank_mask:0xf
    v_add_f32 v125, v125, v125 row_ror:8 row_mask:0xf bank_mask:0xf
    v_add_f32 v116, v116, v116 row_ror:4 row_mask:0xf bank_mask:0xf
    v_add_f32 v117, v117, v117 row_ror:4 row_mask:0xf bank_mask:0xf
    v_add_f32 v124, v124, v124 row_ror:4 row_mask:0xf bank_mask:0xf
    v_add_f32 v125, v125, v125 row_ror:4 row_mask:0xf bank_mask:0xf
    v_add_f32 v116, v116, v116 row_ror:2 row_mask:0xf bank_mask:0xf
    v_add_f32 v117, v117, v117 row_ror:2 row_mask:0xf bank_mask:0xf
    v_add_f32 v124, v124, v124 row_ror:2 row_mask:0xf bank_mask:0xf
    v_add_f32 v125, v125, v125 row_ror:2 row_mask:0xf bank_mask:0xf
    v_add_f32 v116, v116, v116 row_ror:1 row_mask:0xf bank_mask:0xf
    v_add_f32 v117, v117, v117 row_ror:1 row_mask:0xf bank_mask:0xf
    v_add_f32 v124, v124, v124 row_ror:1 row_mask:0xf bank_mask:0xf
    v_add_f32 v125, v125, v125 row_ror:1 row_mask:0xf bank_mask:0xf
    v_mul_f32 v116, 0x3b000000, v116
    v_mul_f32 v117, 0x3b000000, v117
    v_readlane_b32 s40, v116, 0
    v_lshlrev_b32 v156, 16, v48
    v_and_b32 v157, 0xffff0000, v48
    v_lshlrev_b32 v158, 16, v49
    v_and_b32 v159, 0xffff0000, v49
    v_lshlrev_b32 v160, 16, v50
    v_and_b32 v161, 0xffff0000, v50
    v_lshlrev_b32 v162, 16, v51
    v_and_b32 v163, 0xffff0000, v51
    v_pk_add_f32 v[156:157], v[156:157], s[40:41] op_sel_hi:[1,0] neg_lo:[0,1] neg_hi:[0,1]
    v_pk_add_f32 v[158:159], v[158:159], s[40:41] op_sel_hi:[1,0] neg_lo:[0,1] neg_hi:[0,1]
    v_pk_add_f32 v[160:161], v[160:161], s[40:41] op_sel_hi:[1,0] neg_lo:[0,1] neg_hi:[0,1]
    v_pk_add_f32 v[162:163], v[162:163], s[40:41] op_sel_hi:[1,0] neg_lo:[0,1] neg_hi:[0,1]
    v_pk_mul_f32 v[132:133], v[156:157], v[156:157]
    v_pk_fma_f32 v[132:133], v[158:159], v[158:159], v[132:133]
    v_pk_fma_f32 v[132:133], v[160:161], v[160:161], v[132:133]
    v_pk_fma_f32 v[132:133], v[162:163], v[162:163], v[132:133]
    v_add_f32 v132, v132, v133
    v_readlane_b32 s92, v117, 0
    v_lshlrev_b32 v164, 16, v52
    v_and_b32 v165, 0xffff0000, v52
    v_lshlrev_b32 v166, 16, v53
    v_and_b32 v167, 0xffff0000, v53
    v_lshlrev_b32 v168, 16, v54
    v_and_b32 v169, 0xffff0000, v54
    v_lshlrev_b32 v170, 16, v55
    v_and_b32 v171, 0xffff0000, v55
    v_pk_add_f32 v[164:165], v[164:165], s[92:93] op_sel_hi:[1,0] neg_lo:[0,1] neg_hi:[0,1]
    v_pk_add_f32 v[166:167], v[166:167], s[92:93] op_sel_hi:[1,0] neg_lo:[0,1] neg_hi:[0,1]
    v_pk_add_f32 v[168:169], v[168:169], s[92:93] op_sel_hi:[1,0] neg_lo:[0,1] neg_hi:[0,1]
    v_pk_add_f32 v[170:171], v[170:171], s[92:93] op_sel_hi:[1,0] neg_lo:[0,1] neg_hi:[0,1]
    v_pk_mul_f32 v[134:135], v[164:165], v[164:165]
    v_pk_fma_f32 v[134:135], v[166:167], v[166:167], v[134:135]
    v_pk_fma_f32 v[134:135], v[168:169], v[168:169], v[134:135]
    v_pk_fma_f32 v[134:135], v[170:171], v[170:171], v[134:135]
    v_add_f32 v134, v134, v135
    v_readlane_b32 s40, v116, 16
    v_lshlrev_b32 v172, 16, v56
    v_and_b32 v173, 0xffff0000, v56
    v_lshlrev_b32 v174, 16, v57
    v_and_b32 v175, 0xffff0000, v57
    v_lshlrev_b32 v176, 16, v58
    v_and_b32 v177, 0xffff0000, v58
    v_lshlrev_b32 v178, 16, v59
    v_and_b32 v179, 0xffff0000, v59
    v_pk_add_f32 v[172:173], v[172:173], s[40:41] op_sel_hi:[1,0] neg_lo:[0,1] neg_hi:[0,1]
    v_pk_add_f32 v[174:175], v[174:175], s[40:41] op_sel_hi:[1,0] neg_lo:[0,1] neg_hi:[0,1]
    v_pk_add_f32 v[176:177], v[176:177], s[40:41] op_sel_hi:[1,0] neg_lo:[0,1] neg_hi:[0,1]
    v_pk_add_f32 v[178:179], v[178:179], s[40:41] op_sel_hi:[1,0] neg_lo:[0,1] neg_hi:[0,1]
    v_pk_mul_f32 v[136:137], v[172:173], v[172:173]
    v_pk_fma_f32 v[136:137], v[174:175], v[174:175], v[136:137]
    v_pk_fma_f32 v[136:137], v[176:177], v[176:177], v[136:137]
    v_pk_fma_f32 v[136:137], v[178:179], v[178:179], v[136:137]
    v_add_f32 v136, v136, v137
    v_readlane_b32 s92, v117, 16
    v_lshlrev_b32 v180, 16, v60
    v_and_b32 v181, 0xffff0000, v60
    v_lshlrev_b32 v182, 16, v61
    v_and_b32 v183, 0xffff0000, v61
    v_lshlrev_b32 v184, 16, v62
    v_and_b32 v185, 0xffff0000, v62
    v_lshlrev_b32 v186, 16, v63
    v_and_b32 v187, 0xffff0000, v63
    v_pk_add_f32 v[180:181], v[180:181], s[92:93] op_sel_hi:[1,0] neg_lo:[0,1] neg_hi:[0,1]
    v_pk_add_f32 v[182:183], v[182:183], s[92:93] op_sel_hi:[1,0] neg_lo:[0,1] neg_hi:[0,1]
    v_pk_add_f32 v[184:185], v[184:185], s[92:93] op_sel_hi:[1,0] neg_lo:[0,1] neg_hi:[0,1]
    v_pk_add_f32 v[186:187], v[186:187], s[92:93] op_sel_hi:[1,0] neg_lo:[0,1] neg_hi:[0,1]
    v_pk_mul_f32 v[138:139], v[180:181], v[180:181]
    v_pk_fma_f32 v[138:139], v[182:183], v[182:183], v[138:139]
    v_pk_fma_f32 v[138:139], v[184:185], v[184:185], v[138:139]
    v_pk_fma_f32 v[138:139], v[186:187], v[186:187], v[138:139]
    v_add_f32 v138, v138, v139
    v_readlane_b32 s40, v116, 32
    v_lshlrev_b32 v188, 16, v64
    v_and_b32 v189, 0xffff0000, v64
    v_lshlrev_b32 v190, 16, v65
    v_and_b32 v191, 0xffff0000, v65
    v_lshlrev_b32 v192, 16, v66
    v_and_b32 v193, 0xffff0000, v66
    v_lshlrev_b32 v194, 16, v67
    v_and_b32 v195, 0xffff0000, v67
    v_pk_add_f32 v[188:189], v[188:189], s[40:41] op_sel_hi:[1,0] neg_lo:[0,1] neg_hi:[0,1]
    v_pk_add_f32 v[190:191], v[190:191], s[40:41] op_sel_hi:[1,0] neg_lo:[0,1] neg_hi:[0,1]
    v_pk_add_f32 v[192:193], v[192:193], s[40:41] op_sel_hi:[1,0] neg_lo:[0,1] neg_hi:[0,1]
    v_pk_add_f32 v[194:195], v[194:195], s[40:41] op_sel_hi:[1,0] neg_lo:[0,1] neg_hi:[0,1]
    v_pk_mul_f32 v[140:141], v[188:189], v[188:189]
    v_pk_fma_f32 v[140:141], v[190:191], v[190:191], v[140:141]
    v_pk_fma_f32 v[140:141], v[192:193], v[192:193], v[140:141]
    v_pk_fma_f32 v[140:141], v[194:195], v[194:195], v[140:141]
    v_add_f32 v140, v140, v141
    v_readlane_b32 s92, v117, 32
    v_lshlrev_b32 v196, 16, v68
    v_and_b32 v197, 0xffff0000, v68
    v_lshlrev_b32 v198, 16, v69
    v_and_b32 v199, 0xffff0000, v69
    v_lshlrev_b32 v200, 16, v70
    v_and_b32 v201, 0xffff0000, v70
    v_lshlrev_b32 v202, 16, v71
    v_and_b32 v203, 0xffff0000, v71
    v_pk_add_f32 v[196:197], v[196:197], s[92:93] op_sel_hi:[1,0] neg_lo:[0,1] neg_hi:[0,1]
    v_pk_add_f32 v[198:199], v[198:199], s[92:93] op_sel_hi:[1,0] neg_lo:[0,1] neg_hi:[0,1]
    v_pk_add_f32 v[200:201], v[200:201], s[92:93] op_sel_hi:[1,0] neg_lo:[0,1] neg_hi:[0,1]
    v_pk_add_f32 v[202:203], v[202:203], s[92:93] op_sel_hi:[1,0] neg_lo:[0,1] neg_hi:[0,1]
    v_pk_mul_f32 v[142:143], v[196:197], v[196:197]
    v_pk_fma_f32 v[142:143], v[198:199], v[198:199], v[142:143]
    v_pk_fma_f32 v[142:143], v[200:201], v[200:201], v[142:143]
    v_pk_fma_f32 v[142:143], v[202:203], v[202:203], v[142:143]
    v_add_f32 v142, v142, v143
    v_readlane_b32 s40, v116, 48
    v_lshlrev_b32 v204, 16, v72
    v_and_b32 v205, 0xffff0000, v72
    v_lshlrev_b32 v206, 16, v73
    v_and_b32 v207, 0xffff0000, v73
    v_lshlrev_b32 v208, 16, v74
    v_and_b32 v209, 0xffff0000, v74
    v_lshlrev_b32 v210, 16, v75
    v_and_b32 v211, 0xffff0000, v75
    v_pk_add_f32 v[204:205], v[204:205], s[40:41] op_sel_hi:[1,0] neg_lo:[0,1] neg_hi:[0,1]
    v_pk_add_f32 v[206:207], v[206:207], s[40:41] op_sel_hi:[1,0] neg_lo:[0,1] neg_hi:[0,1]
    v_pk_add_f32 v[208:209], v[208:209], s[40:41] op_sel_hi:[1,0] neg_lo:[0,1] neg_hi:[0,1]
    v_pk_add_f32 v[210:211], v[210:211], s[40:41] op_sel_hi:[1,0] neg_lo:[0,1] neg_hi:[0,1]
    v_pk_mul_f32 v[144:145], v[204:205], v[204:205]
    v_pk_fma_f32 v[144:145], v[206:207], v[206:207], v[144:145]
    v_pk_fma_f32 v[144:145], v[208:209], v[208:209], v[144:145]
    v_pk_fma_f32 v[144:145], v[210:211], v[210:211], v[144:145]
    v_add_f32 v144, v144, v145
    v_readlane_b32 s92, v117, 48
    v_lshlrev_b32 v212, 16, v76
    v_and_b32 v213, 0xffff0000, v76
    v_lshlrev_b32 v214, 16, v77
    v_and_b32 v215, 0xffff0000, v77
    v_lshlrev_b32 v216, 16, v78
    v_and_b32 v217, 0xffff0000, v78
    v_lshlrev_b32 v218, 16, v79
    v_and_b32 v219, 0xffff0000, v79
    v_pk_add_f32 v[212:213], v[212:213], s[92:93] op_sel_hi:[1,0] neg_lo:[0,1] neg_hi:[0,1]
    v_pk_add_f32 v[214:215], v[214:215], s[92:93] op_sel_hi:[1,0] neg_lo:[0,1] neg_hi:[0,1]
    v_pk_add_f32 v[216:217], v[216:217], s[92:93] op_sel_hi:[1,0] neg_lo:[0,1] neg_hi:[0,1]
    v_pk_add_f32 v[218:219], v[218:219], s[92:93] op_sel_hi:[1,0] neg_lo:[0,1] neg_hi:[0,1]
    v_pk_mul_f32 v[146:147], v[212:213], v[212:213]
    v_pk_fma_f32 v[146:147], v[214:215], v[214:215], v[146:147]
    v_pk_fma_f32 v[146:147], v[216:217], v[216:217], v[146:147]
    v_pk_fma_f32 v[146:147], v[218:219], v[218:219], v[146:147]
    v_add_f32 v146, v146, v147
    s_waitcnt vmcnt(0)
    v_readfirstlane_b32 s4, v8
    s_nop 0
    s_mul_i32 s4, s4, 0x0019660D
    s_add_u32 s4, s4, 0x3C6EF35F
    v_permlane32_swap_b32 v132, v140
    v_permlane32_swap_b32 v134, v142
    v_permlane32_swap_b32 v136, v144
    v_permlane32_swap_b32 v138, v146
    v_add_f32 v132, v132, v140
    v_add_f32 v134, v134, v142
    v_add_f32 v136, v136, v144
    v_add_f32 v138, v138, v146
    s_nop 0
    v_permlane16_swap_b32 v132, v136
    v_permlane16_swap_b32 v134, v138
    v_add_f32 v132, v132, v136
    v_add_f32 v134, v134, v138
    s_nop 0
    v_add_f32 v132, v132, v132 row_ror:8 row_mask:0xf bank_mask:0xf
    v_add_f32 v134, v134, v134 row_ror:8 row_mask:0xf bank_mask:0xf
    s_nop 0
    v_add_f32 v132, v132, v132 row_ror:4 row_mask:0xf bank_mask:0xf
    v_add_f32 v134, v134, v134 row_ror:4 row_mask:0xf bank_mask:0xf
    s_nop 0
    v_add_f32 v132, v132, v132 row_ror:2 row_mask:0xf bank_mask:0xf
    v_add_f32 v134, v134, v134 row_ror:2 row_mask:0xf bank_mask:0xf
    s_nop 0
    v_add_f32 v132, v132, v132 row_ror:1 row_mask:0xf bank_mask:0xf
    v_add_f32 v134, v134, v134 row_ror:1 row_mask:0xf bank_mask:0xf
    v_mul_f32 v132, 0x3b000000, v132
    v_mul_f32 v134, 0x3b000000, v134
    v_cvt_pk_bf16_f32 v148, v132, v134
    v_cvt_pk_bf16_f32 v149, v124, v125
    v_lshlrev_b32 v132, 16, v148
    v_and_b32 v134, 0xffff0000, v148
    v_lshlrev_b32 v124, 16, v149
    v_and_b32 v125, 0xffff0000, v149
    v_add_f32 v132, 0x3727c5ac, v132
    v_add_f32 v134, 0x3727c5ac, v134
    v_mul_f32 v124, s94, v124
    v_mul_f32 v125, s94, v125
    v_cvt_pk_bf16_f32 v148, v132, v134
    v_lshlrev_b32 v132, 16, v148
    v_and_b32 v134, 0xffff0000, v148
    v_exp_f32 v124, -v124
    v_exp_f32 v125, -v125
    v_sqrt_f32 v132, v132
    v_sqrt_f32 v134, v134
    v_add_f32 v124, 1.0, v124
    v_add_f32 v125, 1.0, v125
    v_cvt_pk_bf16_f32 v148, v132, v134
    v_lshlrev_b32 v132, 16, v148
    v_and_b32 v134, 0xffff0000, v148
    v_rcp_f32 v124, v124
    v_rcp_f32 v125, v125
    v_rcp_f32 v132, v132
    v_rcp_f32 v134, v134
    v_cvt_pk_bf16_f32 v148, v124, v125
    v_lshlrev_b32 v124, 16, v148
    v_and_b32 v125, 0xffff0000, v148
    v_mov_b32 v136, v124
    v_mov_b32 v137, v125
    v_readlane_b32 s40, v132, 0
    s_nop 1
    v_pk_mul_f32 v[156:157], v[156:157], s[40:41] op_sel_hi:[1,0]
    v_pk_mul_f32 v[158:159], v[158:159], s[40:41] op_sel_hi:[1,0]
    v_pk_mul_f32 v[160:161], v[160:161], s[40:41] op_sel_hi:[1,0]
    v_pk_mul_f32 v[162:163], v[162:163], s[40:41] op_sel_hi:[1,0]
    v_readlane_b32 s92, v134, 0
    v_cvt_pk_bf16_f32 v48, v156, v157
    v_cvt_pk_bf16_f32 v49, v158, v159
    v_cvt_pk_bf16_f32 v50, v160, v161
    v_cvt_pk_bf16_f32 v51, v162, v163
    ds_write_b128 v27, v[48:51] offset:0
    v_pk_mul_f32 v[164:165], v[164:165], s[92:93] op_sel_hi:[1,0]
    v_pk_mul_f32 v[166:167], v[166:167], s[92:93] op_sel_hi:[1,0]
    v_pk_mul_f32 v[168:169], v[168:169], s[92:93] op_sel_hi:[1,0]
    v_pk_mul_f32 v[170:171], v[170:171], s[92:93] op_sel_hi:[1,0]
    v_readlane_b32 s40, v132, 16
    v_cvt_pk_bf16_f32 v52, v164, v165
    v_cvt_pk_bf16_f32 v53, v166, v167
    v_cvt_pk_bf16_f32 v54, v168, v169
    v_cvt_pk_bf16_f32 v55, v170, v171
    ds_write_b128 v27, v[52:55] offset:1088
    v_pk_mul_f32 v[172:173], v[172:173], s[40:41] op_sel_hi:[1,0]
    v_pk_mul_f32 v[174:175], v[174:175], s[40:41] op_sel_hi:[1,0]
    v_pk_mul_f32 v[176:177], v[176:177], s[40:41] op_sel_hi:[1,0]
    v_pk_mul_f32 v[178:179], v[178:179], s[40:41] op_sel_hi:[1,0]
    v_readlane_b32 s92, v134, 16
    v_cvt_pk_bf16_f32 v56, v172, v173
    v_cvt_pk_bf16_f32 v57, v174, v175
    v_cvt_pk_bf16_f32 v58, v176, v177
    v_cvt_pk_bf16_f32 v59, v178, v179
    ds_write_b128 v27, v[56:59] offset:2176
    v_pk_mul_f32 v[180:181], v[180:181], s[92:93] op_sel_hi:[1,0]
    v_pk_mul_f32 v[182:183], v[182:183], s[92:93] op_sel_hi:[1,0]
    v_pk_mul_f32 v[184:185], v[184:185], s[92:93] op_sel_hi:[1,0]
    v_pk_mul_f32 v[186:187], v[186:187], s[92:93] op_sel_hi:[1,0]
    v_readlane_b32 s40, v132, 32
    v_cvt_pk_bf16_f32 v60, v180, v181
    v_cvt_pk_bf16_f32 v61, v182, v183
    v_cvt_pk_bf16_f32 v62, v184, v185
    v_cvt_pk_bf16_f32 v63, v186, v187
    ds_write_b128 v27, v[60:63] offset:3264
    v_pk_mul_f32 v[188:189], v[188:189], s[40:41] op_sel_hi:[1,0]
    v_pk_mul_f32 v[190:191], v[190:191], s[40:41] op_sel_hi:[1,0]
    v_pk_mul_f32 v[192:193], v[192:193], s[40:41] op_sel_hi:[1,0]
    v_pk_mul_f32 v[194:195], v[194:195], s[40:41] op_sel_hi:[1,0]
    v_readlane_b32 s92, v134, 32
    v_cvt_pk_bf16_f32 v64, v188, v189
    v_cvt_pk_bf16_f32 v65, v190, v191
    v_cvt_pk_bf16_f32 v66, v192, v193
    v_cvt_pk_bf16_f32 v67, v194, v195
    ds_write_b128 v27, v[64:67] offset:4352
    v_pk_mul_f32 v[196:197], v[196:197], s[92:93] op_sel_hi:[1,0]
    v_pk_mul_f32 v[198:199], v[198:199], s[92:93] op_sel_hi:[1,0]
    v_pk_mul_f32 v[200:201], v[200:201], s[92:93] op_sel_hi:[1,0]
    v_pk_mul_f32 v[202:203], v[202:203], s[92:93] op_sel_hi:[1,0]
    v_readlane_b32 s40, v132, 48
    v_cvt_pk_bf16_f32 v68, v196, v197
    v_cvt_pk_bf16_f32 v69, v198, v199
    v_cvt_pk_bf16_f32 v70, v200, v201
    v_cvt_pk_bf16_f32 v71, v202, v203
    ds_write_b128 v27, v[68:71] offset:5440
    v_pk_mul_f32 v[204:205], v[204:205], s[40:41] op_sel_hi:[1,0]
    v_pk_mul_f32 v[206:207], v[206:207], s[40:41] op_sel_hi:[1,0]
    v_pk_mul_f32 v[208:209], v[208:209], s[40:41] op_sel_hi:[1,0]
    v_pk_mul_f32 v[210:211], v[210:211], s[40:41] op_sel_hi:[1,0]
    v_readlane_b32 s92, v134, 48
    v_cvt_pk_bf16_f32 v72, v204, v205
    v_cvt_pk_bf16_f32 v73, v206, v207
    v_cvt_pk_bf16_f32 v74, v208, v209
    v_cvt_pk_bf16_f32 v75, v210, v211
    ds_write_b128 v27, v[72:75] offset:6528
    v_pk_mul_f32 v[212:213], v[212:213], s[92:93] op_sel_hi:[1,0]
    v_pk_mul_f32 v[214:215], v[214:215], s[92:93] op_sel_hi:[1,0]
    v_pk_mul_f32 v[216:217], v[216:217], s[92:93] op_sel_hi:[1,0]
    v_pk_mul_f32 v[218:219], v[218:219], s[92:93] op_sel_hi:[1,0]
    v_cvt_pk_bf16_f32 v76, v212, v213
    v_cvt_pk_bf16_f32 v77, v214, v215
    v_cvt_pk_bf16_f32 v78, v216, v217
    v_cvt_pk_bf16_f32 v79, v218, v219
    ds_write_b128 v27, v[76:79] offset:7616
    ds_read_b64_tr_b16 v[84:85], v153 offset:0
    ds_read_b64_tr_b16 v[86:87], v153 offset:4352
    ds_read_b64_tr_b16 v[88:89], v153 offset:128
    ds_read_b64_tr_b16 v[90:91], v153 offset:4480
    ds_read_b64_tr_b16 v[92:93], v153 offset:256
    ds_read_b64_tr_b16 v[94:95], v153 offset:4608
    s_waitcnt lgkmcnt(6)
    ds_read_b64_tr_b16 v[96:97], v153 offset:384
    ds_read_b64_tr_b16 v[98:99], v153 offset:4736
    ds_read_b64_tr_b16 v[100:101], v153 offset:512
    ds_read_b64_tr_b16 v[102:103], v153 offset:4864
    ds_read_b64_tr_b16 v[104:105], v153 offset:640
    ds_read_b64_tr_b16 v[106:107], v153 offset:4992
    ds_read_b64_tr_b16 v[108:109], v153 offset:768
    ds_read_b64_tr_b16 v[110:111], v153 offset:5120
    ds_read_b64_tr_b16 v[112:113], v153 offset:896
    ds_read_b64_tr_b16 v[114:115], v153 offset:5248
    s_lshr_b32 s5, s11, 1
    s_lshl_b32 s5, s5, 11
    s_and_b32 s6, s11, 1
    s_lshl_b32 s6, s6, 9
    s_add_u32 s5, s5, s6
    s_lshl_b32 s7, s11, 5
    s_add_u32 s7, s7, 0xc00000
    s_mov_b32 exec_lo, 0x00010001
    s_mov_b32 exec_hi, 0x00010001
    buffer_store_dwordx2 v[136:137], v155, s[84:87], s7 offen sc1
    s_mov_b64 exec, -1
    s_waitcnt lgkmcnt(14)
    buffer_store_dwordx4 v[84:87], v154, s[84:87], s5 offen sc1
    s_add_u32 s5, s5, 262144
    s_waitcnt lgkmcnt(12)
    buffer_store_dwordx4 v[88:91], v154, s[84:87], s5 offen sc1
    s_add_u32 s5, s5, 262144
    s_waitcnt lgkmcnt(10)
    buffer_store_dwordx4 v[92:95], v154, s[84:87], s5 offen sc1
    s_add_u32 s5, s5, 262144
    s_waitcnt lgkmcnt(8)
    buffer_store_dwordx4 v[96:99], v154, s[84:87], s5 offen sc1
    s_add_u32 s5, s5, 262144
    s_waitcnt lgkmcnt(6)
    buffer_store_dwordx4 v[100:103], v154, s[84:87], s5 offen sc1
    s_add_u32 s5, s5, 262144
    s_waitcnt lgkmcnt(4)
    buffer_store_dwordx4 v[104:107], v154, s[84:87], s5 offen sc1
    s_add_u32 s5, s5, 262144
    s_waitcnt lgkmcnt(2)
    buffer_store_dwordx4 v[108:111], v154, s[84:87], s5 offen sc1
    s_add_u32 s5, s5, 262144
    s_waitcnt lgkmcnt(0)
    buffer_store_dwordx4 v[112:115], v154, s[84:87], s5 offen sc1
    s_add_u32 s5, s12, 0xc10000
    s_lshl_b32 s6, s11, 7
    s_add_u32 s6, s6, 0xC70000
    s_cmp_eq_u32 s3, 0
    s_cselect_b32 s5, s5, s6
    s_waitcnt vmcnt(0)
    s_barrier
    v_mov_b32 v2, s4
    s_mov_b32 exec_hi, 0
    buffer_store_dword v2, v42, s[84:87], s5 offen sc1
    s_mov_b64 exec, -1
    s_mul_i32 s92, s28, 7
    s_lshr_b32 s92, s92, 1
    s_and_b32 s93, s29, 7
    s_lshl_b32 s5, s10, 6
    s_lshl_b32 s6, s22, 7
    s_add_u32 s5, s5, s6
    v_lshrrev_b32 v2, 5, v1
    v_lshlrev_b32 v2, 3, v2
    buffer_load_dwordx2 v[28:29], v2, s[64:67], s5 offen offset:0
    buffer_load_dwordx2 v[30:31], v2, s[64:67], s5 offen offset:16
    buffer_load_dwordx2 v[32:33], v2, s[64:67], s5 offen offset:32
    buffer_load_dwordx2 v[34:35], v2, s[64:67], s5 offen offset:48
    v_and_b32 v2, 31, v1
    v_lshlrev_b32 v3, 1, v2
    s_lshl_b32 s5, s29, 7
    s_lshl_b32 s6, s9, 6
    s_add_u32 s5, s5, s6
    buffer_load_ushort v40, v3, s[72:75], s5 offen
    s_add_u32 s90, s15, 458752
    buffer_load_dword v45, v46, s[60:63], s90 offen
    s_add_u32 s90, s15, 917504
    buffer_load_dword v45, v46, s[60:63], s90 offen
    s_add_u32 s90, s15, 1376256
    buffer_load_dword v45, v46, s[60:63], s90 offen
    s_cmp_ge_u32 s97, 28
    s_cbranch_scc1 L_attn
    s_lshl_b32 s38, s3, 11
    s_add_u32 s38, s38, 0xc10000
    v_and_b32 v9, 1920, v7
    s_add_u32 m0, s20, 0
    s_add_u32 s16, s26, 0
    buffer_load_dwordx4 v11, s[60:63], s16 offen lds
    buffer_load_dwordx4 v12, s[60:63], s16 offen offset:1024 lds
    s_add_u32 m0, s20, 2048
    s_add_u32 s16, s26, 57344
    buffer_load_dwordx4 v11, s[60:63], s16 offen lds
    buffer_load_dwordx4 v12, s[60:63], s16 offen offset:1024 lds
    s_add_u32 m0, s20, 4096
    s_add_u32 s16, s26, 114688
    buffer_load_dwordx4 v11, s[60:63], s16 offen lds
    buffer_load_dwordx4 v12, s[60:63], s16 offen offset:1024 lds
    s_add_u32 m0, s20, 6144
    s_add_u32 s16, s26, 172032
    buffer_load_dwordx4 v11, s[60:63], s16 offen lds
    buffer_load_dwordx4 v12, s[60:63], s16 offen offset:1024 lds
    s_add_u32 m0, s20, 8192
    s_add_u32 s16, s26, 229376
    buffer_load_dwordx4 v11, s[60:63], s16 offen lds
    buffer_load_dwordx4 v12, s[60:63], s16 offen offset:1024 lds
    s_waitcnt vmcnt(8)
    ds_read_b64_tr_b16 a[0:1], v13 offset:0
    ds_read_b64_tr_b16 a[2:3], v13 offset:512
    ds_read_b64_tr_b16 a[4:5], v14 offset:0
    ds_read_b64_tr_b16 a[6:7], v14 offset:512
    s_add_u32 m0, s20, 10240
    s_add_u32 s16, s26, 286720
    buffer_load_dwordx4 v11, s[60:63], s16 offen lds
    buffer_load_dwordx4 v12, s[60:63], s16 offen offset:1024 lds
    s_waitcnt vmcnt(8)
    ds_read_b64_tr_b16 a[8:9], v13 offset:2048
    ds_read_b64_tr_b16 a[10:11], v13 offset:2560
    ds_read_b64_tr_b16 a[12:13], v14 offset:2048
    ds_read_b64_tr_b16 a[14:15], v14 offset:2560
    s_add_u32 m0, s20, 12288
    s_add_u32 s16, s26, 344064
    buffer_load_dwordx4 v11, s[60:63], s16 offen lds
    buffer_load_dwordx4 v12, s[60:63], s16 offen offset:1024 lds
    s_waitcnt vmcnt(8)
    ds_read_b64_tr_b16 a[16:17], v13 offset:4096
    ds_read_b64_tr_b16 a[18:19], v13 offset:4608
    ds_read_b64_tr_b16 a[20:21], v14 offset:4096
    ds_read_b64_tr_b16 a[22:23], v14 offset:4608
    s_add_u32 m0, s20, 14336
    s_add_u32 s16, s26, 401408
    buffer_load_dwordx4 v11, s[60:63], s16 offen lds
    buffer_load_dwordx4 v12, s[60:63], s16 offen offset:1024 lds
    s_waitcnt vmcnt(8)
    ds_read_b64_tr_b16 a[24:25], v13 offset:6144
    ds_read_b64_tr_b16 a[26:27], v13 offset:6656
    ds_read_b64_tr_b16 a[28:29], v14 offset:6144
    ds_read_b64_tr_b16 a[30:31], v14 offset:6656
    s_waitcnt lgkmcnt(12)
    s_add_u32 m0, s20, 0
    s_add_u32 s16, s26, 458752
    buffer_load_dwordx4 v11, s[60:63], s16 offen lds
    buffer_load_dwordx4 v12, s[60:63], s16 offen offset:1024 lds
    s_waitcnt vmcnt(8)
    ds_read_b64_tr_b16 a[32:33], v13 offset:8192
    ds_read_b64_tr_b16 a[34:35], v13 offset:8704
    ds_read_b64_tr_b16 a[36:37], v14 offset:8192
    ds_read_b64_tr_b16 a[38:39], v14 offset:8704
    s_waitcnt lgkmcnt(12)
    s_add_u32 m0, s20, 2048
    s_add_u32 s16, s26, 516096
    buffer_load_dwordx4 v11, s[60:63], s16 offen lds
    buffer_load_dwordx4 v12, s[60:63], s16 offen offset:1024 lds
    s_waitcnt vmcnt(8)
    ds_read_b64_tr_b16 a[40:41], v13 offset:10240
    ds_read_b64_tr_b16 a[42:43], v13 offset:10752
    ds_read_b64_tr_b16 a[44:45], v14 offset:10240
    ds_read_b64_tr_b16 a[46:47], v14 offset:10752
    buffer_load_dword v8, v9, s[84:87], s38 offen sc1
    s_waitcnt vmcnt(0)
    v_cmp_ne_u32 vcc, s4, v8
    s_mov_b32 s19, 0x40000
    s_cmp_lg_u64 vcc, 0
    s_cbranch_scc1 L_spin2
L_go2:
    s_add_u32 s17, s25, 0
    buffer_load_dwordx4 a[48:51], v15, s[84:87], s17 offen sc1
    buffer_load_dwordx4 a[52:55], v16, s[84:87], s17 offen sc1
    ds_read_b64_tr_b16 a[56:57], v13 offset:12288
    ds_read_b64_tr_b16 a[58:59], v13 offset:12800
    ds_read_b64_tr_b16 a[60:61], v14 offset:12288
    ds_read_b64_tr_b16 a[62:63], v14 offset:12800
    s_add_u32 s17, s25, 2048
    buffer_load_dwordx4 a[64:67], v15, s[84:87], s17 offen sc1
    buffer_load_dwordx4 a[68:71], v16, s[84:87], s17 offen sc1
    ds_read_b64_tr_b16 a[72:73], v13 offset:14336
    ds_read_b64_tr_b16 a[74:75], v13 offset:14848
    ds_read_b64_tr_b16 a[76:77], v14 offset:14336
    ds_read_b64_tr_b16 a[78:79], v14 offset:14848
    s_add_u32 s17, s25, 4096
    buffer_load_dwordx4 a[80:83], v15, s[84:87], s17 offen sc1
    buffer_load_dwordx4 a[84:87], v16, s[84:87], s17 offen sc1
    ds_read_b64_tr_b16 a[88:89], v13 offset:0
    ds_read_b64_tr_b16 a[90:91], v13 offset:512
    ds_read_b64_tr_b16 a[92:93], v14 offset:0
    ds_read_b64_tr_b16 a[94:95], v14 offset:512
    s_add_u32 s17, s25, 6144
    buffer_load_dwordx4 a[96:99], v15, s[84:87], s17 offen sc1
    buffer_load_dwordx4 a[100:103], v16, s[84:87], s17 offen sc1
    ds_read_b64_tr_b16 a[104:105], v13 offset:2048
    ds_read_b64_tr_b16 a[106:107], v13 offset:2560
    ds_read_b64_tr_b16 a[108:109], v14 offset:2048
    ds_read_b64_tr_b16 a[110:111], v14 offset:2560
    s_add_u32 s17, s25, 8192
    buffer_load_dwordx4 a[112:115], v15, s[84:87], s17 offen sc1
    buffer_load_dwordx4 a[116:119], v16, s[84:87], s17 offen sc1
    s_add_u32 s17, s25, 10240
    buffer_load_dwordx4 a[120:123], v15, s[84:87], s17 offen sc1
    buffer_load_dwordx4 a[124:127], v16, s[84:87], s17 offen sc1
    s_waitcnt vmcnt(10)
    v_mfma_f32_32x32x16_bf16 a[192:207], a[0:3], a[48:51], 0
    s_add_u32 s17, s25, 12288
    buffer_load_dwordx4 a[128:131], v15, s[84:87], s17 offen sc1
    buffer_load_dwordx4 a[132:135], v16, s[84:87], s17 offen sc1
    v_mfma_f32_32x32x16_bf16 a[208:223], a[0:3], a[52:55], 0
    v_mfma_f32_32x32x16_bf16 a[224:239], a[4:7], a[48:51], 0
    s_add_u32 s17, s25, 14336
    buffer_load_dwordx4 a[136:139], v15, s[84:87], s17 offen sc1
    buffer_load_dwordx4 a[140:143], v16, s[84:87], s17 offen sc1
    v_mfma_f32_32x32x16_bf16 a[240:255], a[4:7], a[52:55], 0
    s_waitcnt vmcnt(12)
    v_mfma_f32_32x32x16_bf16 a[192:207], a[8:11], a[64:67], a[192:207]
    s_add_u32 s17, s25, 16384
    buffer_load_dwordx4 a[144:147], v15, s[84:87], s17 offen sc1
    buffer_load_dwordx4 a[148:151], v16, s[84:87], s17 offen sc1
    v_mfma_f32_32x32x16_bf16 a[208:223], a[8:11], a[68:71], a[208:223]
    v_mfma_f32_32x32x16_bf16 a[224:239], a[12:15], a[64:67], a[224:239]
    s_add_u32 s17, s25, 18432
    buffer_load_dwordx4 a[152:155], v15, s[84:87], s17 offen sc1
    buffer_load_dwordx4 a[156:159], v16, s[84:87], s17 offen sc1
    v_mfma_f32_32x32x16_bf16 a[240:255], a[12:15], a[68:71], a[240:255]
    s_waitcnt vmcnt(14) lgkmcnt(15)
    v_mfma_f32_32x32x16_bf16 a[192:207], a[16:19], a[80:83], a[192:207]
    s_add_u32 s17, s25, 20480
    buffer_load_dwordx4 a[160:163], v15, s[84:87], s17 offen sc1
    buffer_load_dwordx4 a[164:167], v16, s[84:87], s17 offen sc1
    v_mfma_f32_32x32x16_bf16 a[208:223], a[16:19], a[84:87], a[208:223]
    v_mfma_f32_32x32x16_bf16 a[224:239], a[20:23], a[80:83], a[224:239]
    s_add_u32 m0, s20, 4096
    s_add_u32 s16, s26, 573440
    buffer_load_dwordx4 v11, s[60:63], s16 offen lds
    buffer_load_dwordx4 v12, s[60:63], s16 offen offset:1024 lds
    v_mfma_f32_32x32x16_bf16 a[240:255], a[20:23], a[84:87], a[240:255]
    s_waitcnt vmcnt(16)
    v_mfma_f32_32x32x16_bf16 a[192:207], a[24:27], a[96:99], a[192:207]
    s_add_u32 s17, s25, 22528
    buffer_load_dwordx4 a[168:171], v15, s[84:87], s17 offen sc1
    buffer_load_dwordx4 a[172:175], v16, s[84:87], s17 offen sc1
    v_mfma_f32_32x32x16_bf16 a[208:223], a[24:27], a[100:103], a[208:223]
    v_mfma_f32_32x32x16_bf16 a[224:239], a[28:31], a[96:99], a[224:239]
    s_add_u32 m0, s20, 6144
    s_add_u32 s16, s26, 630784
    buffer_load_dwordx4 v11, s[60:63], s16 offen lds
    buffer_load_dwordx4 v12, s[60:63], s16 offen offset:1024 lds
    v_mfma_f32_32x32x16_bf16 a[240:255], a[28:31], a[100:103], a[240:255]
    s_waitcnt vmcnt(18)
    v_mfma_f32_32x32x16_bf16 a[192:207], a[32:35], a[112:115], a[192:207]
    s_add_u32 s17, s25, 24576
    buffer_load_dwordx4 a[176:179], v15, s[84:87], s17 offen sc1
    buffer_load_dwordx4 a[180:183], v16, s[84:87], s17 offen sc1
    v_mfma_f32_32x32x16_bf16 a[208:223], a[32:35], a[116:119], a[208:223]
    v_mfma_f32_32x32x16_bf16 a[224:239], a[36:39], a[112:115], a[224:239]
    s_add_u32 m0, s20, 8192
    s_add_u32 s16, s26, 688128
    buffer_load_dwordx4 v11, s[60:63], s16 offen lds
    buffer_load_dwordx4 v12, s[60:63], s16 offen offset:1024 lds
    s_waitcnt vmcnt(8)
    ds_read_b64_tr_b16 a[184:185], v13 offset:4096
    ds_read_b64_tr_b16 a[186:187], v13 offset:4608
    ds_read_b64_tr_b16 a[188:189], v14 offset:4096
    ds_read_b64_tr_b16 a[190:191], v14 offset:4608
    v_mfma_f32_32x32x16_bf16 a[240:255], a[36:39], a[116:119], a[240:255]
    v_mfma_f32_32x32x16_bf16 a[192:207], a[40:43], a[120:123], a[192:207]
    s_add_u32 s17, s25, 26624
    buffer_load_dwordx4 a[0:3], v15, s[84:87], s17 offen sc1
    buffer_load_dwordx4 a[4:7], v16, s[84:87], s17 offen sc1
    v_mfma_f32_32x32x16_bf16 a[208:223], a[40:43], a[124:127], a[208:223]
    v_mfma_f32_32x32x16_bf16 a[224:239], a[44:47], a[120:123], a[224:239]
    s_add_u32 m0, s20, 16384
    s_add_u32 s16, s26, 745472
    buffer_load_dwordx4 v11, s[60:63], s16 offen lds
    buffer_load_dwordx4 v12, s[60:63], s16 offen offset:1024 lds
    s_waitcnt vmcnt(8)
    ds_read_b64_tr_b16 a[48:49], v13 offset:6144
    ds_read_b64_tr_b16 a[50:51], v13 offset:6656
    ds_read_b64_tr_b16 a[52:53], v14 offset:6144
    ds_read_b64_tr_b16 a[54:55], v14 offset:6656
    v_mfma_f32_32x32x16_bf16 a[240:255], a[44:47], a[124:127], a[240:255]
    s_waitcnt lgkmcnt(15)
    v_mfma_f32_32x32x16_bf16 a[192:207], a[56:59], a[128:131], a[192:207]
    s_add_u32 s17, s25, 28672
    buffer_load_dwordx4 a[8:11], v15, s[84:87], s17 offen sc1
    buffer_load_dwordx4 a[12:15], v16, s[84:87], s17 offen sc1
    v_mfma_f32_32x32x16_bf16 a[208:223], a[56:59], a[132:135], a[208:223]
    v_mfma_f32_32x32x16_bf16 a[224:239], a[60:63], a[128:131], a[224:239]
    s_add_u32 m0, s20, 18432
    s_add_u32 s16, s26, 802816
    buffer_load_dwordx4 v11, s[60:63], s16 offen lds
    buffer_load_dwordx4 v12, s[60:63], s16 offen offset:1024 lds
    s_waitcnt vmcnt(8)
    ds_read_b64_tr_b16 a[64:65], v13 offset:8192
    ds_read_b64_tr_b16 a[66:67], v13 offset:8704
    ds_read_b64_tr_b16 a[68:69], v14 offset:8192
    ds_read_b64_tr_b16 a[70:71], v14 offset:8704
    v_mfma_f32_32x32x16_bf16 a[240:255], a[60:63], a[132:135], a[240:255]
    v_mfma_f32_32x32x16_bf16 a[192:207], a[72:75], a[136:139], a[192:207]
    s_add_u32 s17, s25, 30720
    buffer_load_dwordx4 a[16:19], v15, s[84:87], s17 offen sc1
    buffer_load_dwordx4 a[20:23], v16, s[84:87], s17 offen sc1
    v_mfma_f32_32x32x16_bf16 a[208:223], a[72:75], a[140:143], a[208:223]
    v_mfma_f32_32x32x16_bf16 a[224:239], a[76:79], a[136:139], a[224:239]
    s_add_u32 m0, s20, 20480
    s_add_u32 s16, s26, 860160
    buffer_load_dwordx4 v11, s[60:63], s16 offen lds
    buffer_load_dwordx4 v12, s[60:63], s16 offen offset:1024 lds
    s_waitcnt vmcnt(8)
    ds_read_b64_tr_b16 a[80:81], v13 offset:16384
    ds_read_b64_tr_b16 a[82:83], v13 offset:16896
    ds_read_b64_tr_b16 a[84:85], v14 offset:16384
    ds_read_b64_tr_b16 a[86:87], v14 offset:16896
    v_mfma_f32_32x32x16_bf16 a[240:255], a[76:79], a[140:143], a[240:255]
    s_waitcnt lgkmcnt(15)
    v_mfma_f32_32x32x16_bf16 a[192:207], a[88:91], a[144:147], a[192:207]
    v_mfma_f32_32x32x16_bf16 a[208:223], a[88:91], a[148:151], a[208:223]
    v_mfma_f32_32x32x16_bf16 a[224:239], a[92:95], a[144:147], a[224:239]
    v_mfma_f32_32x32x16_bf16 a[240:255], a[92:95], a[148:151], a[240:255]
    s_lshl_b32 s36, s11, 7
    s_add_u32 s36, s36, 0xC70000
L_p2:
    s_waitcnt lgkmcnt(0)
    v_mfma_f32_32x32x16_bf16 a[192:207], a[104:107], a[152:155], a[192:207]
    s_add_u32 s17, s25, 32768
    buffer_load_dwordx4 a[24:27], v15, s[84:87], s17 offen sc1
    buffer_load_dwordx4 a[28:31], v16, s[84:87], s17 offen sc1
    s_add_u32 m0, s20, 22528
    s_add_u32 s16, s26, 917504
    buffer_load_dwordx4 v11, s[60:63], s16 offen lds
    v_mfma_f32_32x32x16_bf16 a[208:223], a[104:107], a[156:159], a[208:223]
    buffer_load_dwordx4 v12, s[60:63], s16 offen offset:1024 lds
    s_add_u32 s17, s25, 34816
    buffer_load_dwordx4 a[96:99], v15, s[84:87], s17 offen sc1
    buffer_load_dwordx4 a[100:103], v16, s[84:87], s17 offen sc1
    v_mfma_f32_32x32x16_bf16 a[224:239], a[108:111], a[152:155], a[224:239]
    s_add_u32 m0, s20, 10240
    s_add_u32 s16, s26, 974848
    buffer_load_dwordx4 v11, s[60:63], s16 offen lds
    buffer_load_dwordx4 v12, s[60:63], s16 offen offset:1024 lds
    s_add_u32 s17, s25, 36864
    buffer_load_dwordx4 a[32:35], v15, s[84:87], s17 offen sc1
    v_mfma_f32_32x32x16_bf16 a[240:255], a[108:111], a[156:159], a[240:255]
    buffer_load_dwordx4 a[36:39], v16, s[84:87], s17 offen sc1
    s_waitcnt vmcnt(14)
    ds_read_b64_tr_b16 a[112:113], v13 offset:18432
    ds_read_b64_tr_b16 a[114:115], v13 offset:18944
    ds_read_b64_tr_b16 a[116:117], v14 offset:18432
    ds_read_b64_tr_b16 a[118:119], v14 offset:18944
    s_waitcnt vmcnt(10)
    v_mov_b32 v2, s4
    s_mov_b32 exec_hi, 0
    buffer_store_dword v2, v42, s[84:87], s36 offen sc1
    s_mov_b64 exec, -1
    v_mfma_f32_32x32x16_bf16 a[192:207], a[184:187], a[160:163], a[192:207]
    s_add_u32 m0, s20, 12288
    s_add_u32 s16, s26, 1032192
    buffer_load_dwordx4 v11, s[60:63], s16 offen lds
    v_mfma_f32_32x32x16_bf16 a[208:223], a[184:187], a[164:167], a[208:223]
    buffer_load_dwordx4 v12, s[60:63], s16 offen offset:1024 lds
    s_add_u32 s17, s25, 38912
    buffer_load_dwordx4 a[40:43], v15, s[84:87], s17 offen sc1
    v_mfma_f32_32x32x16_bf16 a[224:239], a[188:191], a[160:163], a[224:239]
    buffer_load_dwordx4 a[44:47], v16, s[84:87], s17 offen sc1
    ds_read_b64_tr_b16 a[120:121], v13 offset:20480
    v_mfma_f32_32x32x16_bf16 a[240:255], a[188:191], a[164:167], a[240:255]
    ds_read_b64_tr_b16 a[122:123], v13 offset:20992
    ds_read_b64_tr_b16 a[124:125], v14 offset:20480
    ds_read_b64_tr_b16 a[126:127], v14 offset:20992
    v_mfma_f32_32x32x16_bf16 a[192:207], a[48:51], a[168:171], a[192:207]
    s_add_u32 m0, s20, 14336
    s_add_u32 s16, s26, 1089536
    buffer_load_dwordx4 v11, s[60:63], s16 offen lds
    buffer_load_dwordx4 v12, s[60:63], s16 offen offset:1024 lds
    s_add_u32 s17, s25, 40960
    buffer_load_dwordx4 a[56:59], v15, s[84:87], s17 offen sc1
    buffer_load_dwordx4 a[60:63], v16, s[84:87], s17 offen sc1
    s_waitcnt vmcnt(15)
    v_mfma_f32_32x32x16_bf16 a[208:223], a[48:51], a[172:175], a[208:223]
    ds_read_b64_tr_b16 a[128:129], v13 offset:22528
    ds_read_b64_tr_b16 a[130:131], v13 offset:23040
    ds_read_b64_tr_b16 a[132:133], v14 offset:22528
    ds_read_b64_tr_b16 a[134:135], v14 offset:23040
    s_xor_b32 s5, s3, 1
    s_mul_i32 s5, s5, 40960
    v_add_u32 v172, s5, v6
    s_xor_b32 s5, s3, 2
    s_mul_i32 s5, s5, 40960
    v_add_u32 v173, s5, v6
    s_xor_b32 s5, s3, 3
    s_mul_i32 s5, s5, 40960
    v_add_u32 v174, s5, v6
    v_lshlrev_b32 v108, 16, v28
    v_and_b32 v109, 0xffff0000, v28
    v_mfma_f32_32x32x16_bf16 a[224:239], a[52:55], a[168:171], a[224:239]
    v_lshlrev_b32 v110, 16, v29
    v_and_b32 v111, 0xffff0000, v29
    v_lshlrev_b32 v112, 16, v30
    v_and_b32 v113, 0xffff0000, v30
    v_lshlrev_b32 v114, 16, v31
    v_and_b32 v115, 0xffff0000, v31
    v_lshlrev_b32 v116, 16, v32
    v_and_b32 v117, 0xffff0000, v32
    v_lshlrev_b32 v118, 16, v33
    v_and_b32 v119, 0xffff0000, v33
    v_lshlrev_b32 v120, 16, v34
    v_and_b32 v121, 0xffff0000, v34
    v_lshlrev_b32 v122, 16, v35
    v_and_b32 v123, 0xffff0000, v35
    s_mov_b32 s36, 0xbdd2d3e8
    s_mov_b32 s37, 0xbdd2d3e8
    v_mfma_f32_32x32x16_bf16 a[240:255], a[52:55], a[172:175], a[240:255]
    v_mov_b32 v140, 0xc0135761
    s_mul_i32 s5, s21, 112
    s_lshl_b32 s6, s22, 2
    s_add_u32 s5, s5, s6
    s_and_b32 s6, s3, 2
    s_add_u32 s5, s5, s6
    s_lshl_b32 s5, s5, 1
    s_add_u32 s5, s5, s9
    s_lshl_b32 s5, s5, 10
    s_add_u32 s15, s5, 0x400000
    s_lshl_b32 s5, s21, 5
    s_add_u32 s5, s5, s22
    s_lshl_b32 s5, s5, 2
    s_add_u32 s5, s5, s3
    s_lshl_b32 s5, s5, 7
    s_add_u32 s42, s5, 0xc40000
    v_mfma_f32_32x32x16_bf16 a[192:207], a[64:67], a[176:179], a[192:207]
    s_add_u32 m0, s20, 0
    s_add_u32 s16, s26, 1146880
    buffer_load_dwordx4 v11, s[60:63], s16 offen lds
    v_mfma_f32_32x32x16_bf16 a[208:223], a[64:67], a[180:183], a[208:223]
    buffer_load_dwordx4 v12, s[60:63], s16 offen offset:1024 lds
    s_add_u32 s17, s25, 43008
    buffer_load_dwordx4 a[72:75], v15, s[84:87], s17 offen sc1
    v_mfma_f32_32x32x16_bf16 a[224:239], a[68:71], a[176:179], a[224:239]
    buffer_load_dwordx4 a[76:79], v16, s[84:87], s17 offen sc1
    s_waitcnt vmcnt(15)
    v_mfma_f32_32x32x16_bf16 a[240:255], a[68:71], a[180:183], a[240:255]
    ds_read_b64_tr_b16 a[136:137], v13 offset:10240
    ds_read_b64_tr_b16 a[138:139], v13 offset:10752
    ds_read_b64_tr_b16 a[140:141], v14 offset:10240
    ds_read_b64_tr_b16 a[142:143], v14 offset:10752
    v_mfma_f32_32x32x16_bf16 a[192:207], a[80:83], a[0:3], a[192:207]
    s_add_u32 m0, s20, 2048
    s_add_u32 s16, s26, 1204224
    buffer_load_dwordx4 v11, s[60:63], s16 offen lds
    v_mfma_f32_32x32x16_bf16 a[208:223], a[80:83], a[4:7], a[208:223]
    buffer_load_dwordx4 v12, s[60:63], s16 offen offset:1024 lds
    s_add_u32 s17, s25, 45056
    buffer_load_dwordx4 a[88:91], v15, s[84:87], s17 offen sc1
    v_mfma_f32_32x32x16_bf16 a[224:239], a[84:87], a[0:3], a[224:239]
    buffer_load_dwordx4 a[92:95], v16, s[84:87], s17 offen sc1
    s_waitcnt vmcnt(14)
    v_mfma_f32_32x32x16_bf16 a[240:255], a[84:87], a[4:7], a[240:255]
    ds_read_b64_tr_b16 a[144:145], v13 offset:12288
    ds_read_b64_tr_b16 a[146:147], v13 offset:12800
    ds_read_b64_tr_b16 a[148:149], v14 offset:12288
    ds_read_b64_tr_b16 a[150:151], v14 offset:12800
    s_waitcnt lgkmcnt(15)
    v_mfma_f32_32x32x16_bf16 a[192:207], a[112:115], a[8:11], a[192:207]
    s_add_u32 m0, s20, 24576
    s_add_u32 s16, s26, 1261568
    buffer_load_dwordx4 v11, s[60:63], s16 offen lds
    v_mfma_f32_32x32x16_bf16 a[208:223], a[112:115], a[12:15], a[208:223]
    buffer_load_dwordx4 v12, s[60:63], s16 offen offset:1024 lds
    s_add_u32 s17, s25, 47104
    buffer_load_dwordx4 a[104:107], v15, s[84:87], s17 offen sc1
    v_mfma_f32_32x32x16_bf16 a[224:239], a[116:119], a[8:11], a[224:239]
    buffer_load_dwordx4 a[108:111], v16, s[84:87], s17 offen sc1
    s_waitcnt vmcnt(14)
    v_mfma_f32_32x32x16_bf16 a[240:255], a[116:119], a[12:15], a[240:255]
    ds_read_b64_tr_b16 a[152:153], v13 offset:14336
    ds_read_b64_tr_b16 a[154:155], v13 offset:14848
    ds_read_b64_tr_b16 a[156:157], v14 offset:14336
    ds_read_b64_tr_b16 a[158:159], v14 offset:14848
    s_waitcnt lgkmcnt(15)
    v_mfma_f32_32x32x16_bf16 a[192:207], a[120:123], a[16:19], a[192:207]
    s_add_u32 m0, s20, 26624
    s_add_u32 s16, s26, 1318912
    buffer_load_dwordx4 v11, s[60:63], s16 offen lds
    v_mfma_f32_32x32x16_bf16 a[208:223], a[120:123], a[20:23], a[208:223]
    buffer_load_dwordx4 v12, s[60:63], s16 offen offset:1024 lds
    s_add_u32 s17, s25, 49152
    buffer_load_dwordx4 a[184:187], v15, s[84:87], s17 offen sc1
    v_mfma_f32_32x32x16_bf16 a[224:239], a[124:127], a[16:19], a[224:239]
    buffer_load_dwordx4 a[188:191], v16, s[84:87], s17 offen sc1
    s_waitcnt vmcnt(14)
    v_mfma_f32_32x32x16_bf16 a[240:255], a[124:127], a[20:23], a[240:255]
    ds_read_b64_tr_b16 a[160:161], v13 offset:0
    ds_read_b64_tr_b16 a[162:163], v13 offset:512
    ds_read_b64_tr_b16 a[164:165], v14 offset:0
    ds_read_b64_tr_b16 a[166:167], v14 offset:512
    s_waitcnt lgkmcnt(15)
    v_mfma_f32_32x32x16_bf16 a[192:207], a[128:131], a[24:27], a[192:207]
    s_add_u32 m0, s20, 4096
    s_add_u32 s16, s26, 1376256
    buffer_load_dwordx4 v11, s[60:63], s16 offen lds
    v_mfma_f32_32x32x16_bf16 a[208:223], a[128:131], a[28:31], a[208:223]
    buffer_load_dwordx4 v12, s[60:63], s16 offen offset:1024 lds
    s_add_u32 s17, s25, 51200
    buffer_load_dwordx4 a[48:51], v15, s[84:87], s17 offen sc1
    v_mfma_f32_32x32x16_bf16 a[224:239], a[132:135], a[24:27], a[224:239]
    buffer_load_dwordx4 a[52:55], v16, s[84:87], s17 offen sc1
    s_waitcnt vmcnt(14)
    v_mfma_f32_32x32x16_bf16 a[240:255], a[132:135], a[28:31], a[240:255]
    ds_read_b64_tr_b16 a[168:169], v13 offset:2048
    ds_read_b64_tr_b16 a[170:171], v13 offset:2560
    ds_read_b64_tr_b16 a[172:173], v14 offset:2048
    ds_read_b64_tr_b16 a[174:175], v14 offset:2560
    s_waitcnt lgkmcnt(15)
    v_mfma_f32_32x32x16_bf16 a[192:207], a[136:139], a[96:99], a[192:207]
    s_add_u32 m0, s20, 6144
    s_add_u32 s16, s26, 1433600
    buffer_load_dwordx4 v11, s[60:63], s16 offen lds
    v_mfma_f32_32x32x16_bf16 a[208:223], a[136:139], a[100:103], a[208:223]
    buffer_load_dwordx4 v12, s[60:63], s16 offen offset:1024 lds
    s_add_u32 s17, s25, 53248
    buffer_load_dwordx4 a[64:67], v15, s[84:87], s17 offen sc1
    v_mfma_f32_32x32x16_bf16 a[224:239], a[140:143], a[96:99], a[224:239]
    buffer_load_dwordx4 a[68:71], v16, s[84:87], s17 offen sc1
    s_waitcnt vmcnt(14)
    v_mfma_f32_32x32x16_bf16 a[240:255], a[140:143], a[100:103], a[240:255]
    ds_read_b64_tr_b16 a[176:177], v13 offset:24576
    ds_read_b64_tr_b16 a[178:179], v13 offset:25088
    ds_read_b64_tr_b16 a[180:181], v14 offset:24576
    ds_read_b64_tr_b16 a[182:183], v14 offset:25088
    s_waitcnt lgkmcnt(15)
    v_mfma_f32_32x32x16_bf16 a[192:207], a[144:147], a[32:35], a[192:207]
    s_add_u32 m0, s20, 8192
    s_add_u32 s16, s26, 1490944
    buffer_load_dwordx4 v11, s[60:63], s16 offen lds
    v_mfma_f32_32x32x16_bf16 a[208:223], a[144:147], a[36:39], a[208:223]
    buffer_load_dwordx4 v12, s[60:63], s16 offen offset:1024 lds
    s_add_u32 s17, s25, 55296
    buffer_load_dwordx4 a[80:83], v15, s[84:87], s17 offen sc1
    v_mfma_f32_32x32x16_bf16 a[224:239], a[148:151], a[32:35], a[224:239]
    buffer_load_dwordx4 a[84:87], v16, s[84:87], s17 offen sc1
    s_waitcnt vmcnt(14)
    v_mfma_f32_32x32x16_bf16 a[240:255], a[148:151], a[36:39], a[240:255]
    ds_read_b64_tr_b16 a[0:1], v13 offset:26624
    ds_read_b64_tr_b16 a[2:3], v13 offset:27136
    ds_read_b64_tr_b16 a[4:5], v14 offset:26624
    ds_read_b64_tr_b16 a[6:7], v14 offset:27136
    s_waitcnt lgkmcnt(15)
    v_mfma_f32_32x32x16_bf16 a[192:207], a[152:155], a[40:43], a[192:207]
    s_add_u32 m0, s20, 16384
    s_add_u32 s16, s26, 1548288
    buffer_load_dwordx4 v11, s[60:63], s16 offen lds
    v_mfma_f32_32x32x16_bf16 a[208:223], a[152:155], a[44:47], a[208:223]
    buffer_load_dwordx4 v12, s[60:63], s16 offen offset:1024 lds
    s_add_u32 s17, s25, 57344
    buffer_load_dwordx4 a[112:115], v15, s[84:87], s17 offen sc1
    v_mfma_f32_32x32x16_bf16 a[224:239], a[156:159], a[40:43], a[224:239]
    buffer_load_dwordx4 a[116:119], v16, s[84:87], s17 offen sc1
    s_waitcnt vmcnt(14)
    v_mfma_f32_32x32x16_bf16 a[240:255], a[156:159], a[44:47], a[240:255]
    ds_read_b64_tr_b16 a[8:9], v13 offset:4096
    ds_read_b64_tr_b16 a[10:11], v13 offset:4608
    ds_read_b64_tr_b16 a[12:13], v14 offset:4096
    ds_read_b64_tr_b16 a[14:15], v14 offset:4608
    s_waitcnt lgkmcnt(15)
    v_mfma_f32_32x32x16_bf16 a[192:207], a[160:163], a[56:59], a[192:207]
    s_add_u32 m0, s20, 18432
    s_add_u32 s16, s26, 1605632
    buffer_load_dwordx4 v11, s[60:63], s16 offen lds
    v_mfma_f32_32x32x16_bf16 a[208:223], a[160:163], a[60:63], a[208:223]
    buffer_load_dwordx4 v12, s[60:63], s16 offen offset:1024 lds
    s_add_u32 s17, s25, 59392
    buffer_load_dwordx4 a[120:123], v15, s[84:87], s17 offen sc1
    v_mfma_f32_32x32x16_bf16 a[224:239], a[164:167], a[56:59], a[224:239]
    buffer_load_dwordx4 a[124:127], v16, s[84:87], s17 offen sc1
    s_waitcnt vmcnt(14)
    v_mfma_f32_32x32x16_bf16 a[240:255], a[164:167], a[60:63], a[240:255]
    ds_read_b64_tr_b16 a[16:17], v13 offset:6144
    ds_read_b64_tr_b16 a[18:19], v13 offset:6656
    ds_read_b64_tr_b16 a[20:21], v14 offset:6144
    ds_read_b64_tr_b16 a[22:23], v14 offset:6656
    s_waitcnt lgkmcnt(15)
    v_mfma_f32_32x32x16_bf16 a[192:207], a[168:171], a[72:75], a[192:207]
    s_add_u32 m0, s20, 20480
    s_add_u32 s16, s26, 1662976
    buffer_load_dwordx4 v11, s[60:63], s16 offen lds
    v_mfma_f32_32x32x16_bf16 a[208:223], a[168:171], a[76:79], a[208:223]
    buffer_load_dwordx4 v12, s[60:63], s16 offen offset:1024 lds
    s_add_u32 s17, s25, 61440
    buffer_load_dwordx4 a[128:131], v15, s[84:87], s17 offen sc1
    v_mfma_f32_32x32x16_bf16 a[224:239], a[172:175], a[72:75], a[224:239]
    buffer_load_dwordx4 a[132:135], v16, s[84:87], s17 offen sc1
    s_waitcnt vmcnt(14)
    v_mfma_f32_32x32x16_bf16 a[240:255], a[172:175], a[76:79], a[240:255]
    ds_read_b64_tr_b16 a[24:25], v13 offset:8192
    ds_read_b64_tr_b16 a[26:27], v13 offset:8704
    ds_read_b64_tr_b16 a[28:29], v14 offset:8192
    ds_read_b64_tr_b16 a[30:31], v14 offset:8704
    s_waitcnt lgkmcnt(15)
    v_mfma_f32_32x32x16_bf16 a[192:207], a[176:179], a[88:91], a[192:207]
    s_add_u32 m0, s20, 22528
    s_add_u32 s16, s26, 1720320
    buffer_load_dwordx4 v11, s[60:63], s16 offen lds
    v_mfma_f32_32x32x16_bf16 a[208:223], a[176:179], a[92:95], a[208:223]
    buffer_load_dwordx4 v12, s[60:63], s16 offen offset:1024 lds
    s_add_u32 s17, s25, 63488
    buffer_load_dwordx4 a[136:139], v15, s[84:87], s17 offen sc1
    v_mfma_f32_32x32x16_bf16 a[224:239], a[180:183], a[88:91], a[224:239]
    buffer_load_dwordx4 a[140:143], v16, s[84:87], s17 offen sc1
    s_waitcnt vmcnt(14)
    v_mfma_f32_32x32x16_bf16 a[240:255], a[180:183], a[92:95], a[240:255]
    ds_read_b64_tr_b16 a[96:97], v13 offset:16384
    ds_read_b64_tr_b16 a[98:99], v13 offset:16896
    ds_read_b64_tr_b16 a[100:101], v14 offset:16384
    ds_read_b64_tr_b16 a[102:103], v14 offset:16896
    s_waitcnt lgkmcnt(15)
    v_mfma_f32_32x32x16_bf16 a[192:207], a[0:3], a[104:107], a[192:207]
    s_add_u32 m0, s20, 10240
    s_add_u32 s16, s26, 1777664
    buffer_load_dwordx4 v11, s[60:63], s16 offen lds
    buffer_load_dwordx4 v12, s[60:63], s16 offen offset:1024 lds
    v_mfma_f32_32x32x16_bf16 a[208:223], a[0:3], a[108:111], a[208:223]
    s_add_u32 m0, s20, 12288
    s_add_u32 s16, s92, 0
    s_sub_u32 s90, s16, 28
    s_cselect_b32 s16, s16, s90
    s_lshl_b32 s16, s16, 16
    s_add_u32 s16, s16, s33
    v_mfma_f32_32x32x16_bf16 a[224:239], a[4:7], a[104:107], a[224:239]
    buffer_load_dwordx4 v19, s[68:71], s16 offen lds
    buffer_load_dwordx4 v20, s[68:71], s16 offen offset:1024 lds
    v_mfma_f32_32x32x16_bf16 a[240:255], a[4:7], a[108:111], a[240:255]
    s_waitcnt vmcnt(14)
    ds_read_b64_tr_b16 a[144:145], v13 offset:18432
    ds_read_b64_tr_b16 a[146:147], v13 offset:18944
    ds_read_b64_tr_b16 a[148:149], v14 offset:18432
    ds_read_b64_tr_b16 a[150:151], v14 offset:18944
    s_waitcnt lgkmcnt(15)
    v_mfma_f32_32x32x16_bf16 a[208:223], a[8:11], a[188:191], a[208:223]
    v_mfma_f32_32x32x16_bf16 a[224:239], a[12:15], a[184:187], a[224:239]
    v_mfma_f32_32x32x16_bf16 a[240:255], a[12:15], a[188:191], a[240:255]
    s_waitcnt lgkmcnt(12)
    v_mfma_f32_32x32x16_bf16 a[208:223], a[16:19], a[52:55], a[208:223]
    v_mfma_f32_32x32x16_bf16 a[224:239], a[20:23], a[48:51], a[224:239]
    v_mfma_f32_32x32x16_bf16 a[240:255], a[20:23], a[52:55], a[240:255]
    s_waitcnt lgkmcnt(8)
    v_mfma_f32_32x32x16_bf16 a[208:223], a[24:27], a[68:71], a[208:223]
    s_add_u32 m0, s20, 14336
    s_add_u32 s16, s92, 1
    s_sub_u32 s90, s16, 28
    s_cselect_b32 s16, s16, s90
    s_lshl_b32 s16, s16, 16
    s_add_u32 s16, s16, s33
    v_mfma_f32_32x32x16_bf16 a[224:239], a[28:31], a[64:67], a[224:239]
    buffer_load_dwordx4 v19, s[68:71], s16 offen lds
    buffer_load_dwordx4 v20, s[68:71], s16 offen offset:1024 lds
    s_waitcnt vmcnt(12)
    v_mfma_f32_32x32x16_bf16 a[240:255], a[28:31], a[68:71], a[240:255]
    ds_read_b64_tr_b16 a[32:33], v13 offset:20480
    ds_read_b64_tr_b16 a[34:35], v13 offset:20992
    ds_read_b64_tr_b16 a[36:37], v14 offset:20480
    ds_read_b64_tr_b16 a[38:39], v14 offset:20992
    s_waitcnt lgkmcnt(8)
    v_mfma_f32_32x32x16_bf16 a[208:223], a[96:99], a[84:87], a[208:223]
    v_mfma_f32_32x32x16_bf16 a[224:239], a[100:103], a[80:83], a[224:239]
    v_mfma_f32_32x32x16_bf16 a[240:255], a[100:103], a[84:87], a[240:255]
    s_waitcnt lgkmcnt(4)
    v_mfma_f32_32x32x16_bf16 a[208:223], a[144:147], a[116:119], a[208:223]
    s_add_u32 m0, s20, 0
    s_add_u32 s16, s92, 2
    s_sub_u32 s90, s16, 28
    s_cselect_b32 s16, s16, s90
    s_lshl_b32 s16, s16, 16
    s_add_u32 s16, s16, s33
    v_mfma_f32_32x32x16_bf16 a[224:239], a[148:151], a[112:115], a[224:239]
    buffer_load_dwordx4 v19, s[68:71], s16 offen lds
    buffer_load_dwordx4 v20, s[68:71], s16 offen offset:1024 lds
    s_waitcnt vmcnt(10)
    v_mfma_f32_32x32x16_bf16 a[240:255], a[148:151], a[116:119], a[240:255]
    ds_read_b64_tr_b16 a[152:153], v13 offset:22528
    ds_read_b64_tr_b16 a[154:155], v13 offset:23040
    ds_read_b64_tr_b16 a[156:157], v14 offset:22528
    ds_read_b64_tr_b16 a[158:159], v14 offset:23040
    s_waitcnt lgkmcnt(4)
    v_mfma_f32_32x32x16_bf16 a[208:223], a[32:35], a[124:127], a[208:223]
    v_mfma_f32_32x32x16_bf16 a[224:239], a[36:39], a[120:123], a[224:239]
    v_mfma_f32_32x32x16_bf16 a[240:255], a[36:39], a[124:127], a[240:255]
    s_waitcnt lgkmcnt(0)
    v_mfma_f32_32x32x16_bf16 a[208:223], a[152:155], a[132:135], a[208:223]
    s_waitcnt vmcnt(6)
    ds_read_b64_tr_b16 a[40:41], v13 offset:10240
    ds_read_b64_tr_b16 a[42:43], v13 offset:10752
    ds_read_b64_tr_b16 a[44:45], v14 offset:10240
    ds_read_b64_tr_b16 a[46:47], v14 offset:10752
    v_mfma_f32_32x32x16_bf16 a[224:239], a[156:159], a[128:131], a[224:239]
    s_add_u32 m0, s20, 2048
    s_add_u32 s16, s92, 3
    s_sub_u32 s90, s16, 28
    s_cselect_b32 s16, s16, s90
    s_lshl_b32 s16, s16, 16
    s_add_u32 s16, s16, s33
    v_mfma_f32_32x32x16_bf16 a[240:255], a[156:159], a[132:135], a[240:255]
    buffer_load_dwordx4 v19, s[68:71], s16 offen lds
    buffer_load_dwordx4 v20, s[68:71], s16 offen offset:1024 lds
    s_waitcnt lgkmcnt(0)
    v_mfma_f32_32x32x16_bf16 a[208:223], a[40:43], a[140:143], a[208:223]
    v_mfma_f32_32x32x16_bf16 a[224:239], a[44:47], a[136:139], a[224:239]
    v_mfma_f32_32x32x16_bf16 a[240:255], a[44:47], a[140:143], a[240:255]
    v_mfma_f32_32x32x16_bf16 a[192:207], a[8:11], a[184:187], a[192:207]
    s_add_u32 m0, s20, 24576
    s_add_u32 s16, s92, 4
    s_sub_u32 s90, s16, 28
    s_cselect_b32 s16, s16, s90
    s_lshl_b32 s16, s16, 16
    s_add_u32 s16, s16, s33
    buffer_load_dwordx4 v19, s[68:71], s16 offen lds
    buffer_load_dwordx4 v20, s[68:71], s16 offen offset:1024 lds
    s_waitcnt vmcnt(8)
    ds_read_b64_tr_b16 a[160:161], v23 offset:12288
    ds_read_b64_tr_b16 a[162:163], v23 offset:13312
    ds_read_b64_tr_b16 a[164:165], v24 offset:12288
    ds_read_b64_tr_b16 a[166:167], v24 offset:13312
    v_mfma_f32_32x32x16_bf16 a[192:207], a[16:19], a[48:51], a[192:207]
    ds_write_b128 v27, a[208:211] offset:28672
    ds_write_b128 v27, a[212:215] offset:29696
    v_mfma_f32_32x32x16_bf16 a[192:207], a[24:27], a[64:67], a[192:207]
    ds_write_b128 v27, a[216:219] offset:30720
    ds_write_b128 v27, a[220:223] offset:31744
    v_mfma_f32_32x32x16_bf16 a[192:207], a[96:99], a[80:83], a[192:207]
    s_add_u32 m0, s20, 26624
    s_add_u32 s16, s92, 5
    s_sub_u32 s90, s16, 28
    s_cselect_b32 s16, s16, s90
    s_lshl_b32 s16, s16, 16
    s_add_u32 s16, s16, s33
    buffer_load_dwordx4 v19, s[68:71], s16 offen lds
    buffer_load_dwordx4 v20, s[68:71], s16 offen offset:1024 lds
    s_waitcnt vmcnt(8)
    ds_read_b64_tr_b16 a[56:57], v23 offset:14336
    ds_read_b64_tr_b16 a[58:59], v23 offset:15360
    ds_read_b64_tr_b16 a[60:61], v24 offset:14336
    ds_read_b64_tr_b16 a[62:63], v24 offset:15360
    ds_write_b128 v27, a[224:227] offset:32768
    ds_write_b128 v27, a[228:231] offset:33792
    v_mfma_f32_32x32x16_bf16 a[192:207], a[144:147], a[112:115], a[192:207]
    ds_write_b128 v27, a[232:235] offset:34816
    ds_write_b128 v27, a[236:239] offset:35840
    v_mfma_f32_32x32x16_bf16 a[192:207], a[32:35], a[120:123], a[192:207]
    ds_write_b128 v27, a[240:243] offset:36864
    ds_write_b128 v27, a[244:247] offset:37888
    v_mfma_f32_32x32x16_bf16 a[192:207], a[152:155], a[128:131], a[192:207]
    ds_write_b128 v27, a[248:251] offset:38912
    ds_write_b128 v27, a[252:255] offset:39936
    v_mfma_f32_32x32x16_bf16 a[192:207], a[40:43], a[136:139], a[192:207]
    s_waitcnt lgkmcnt(0)
    s_barrier
    ds_read_b128 v[60:63], v172 offset:28672
    ds_read_b128 v[64:67], v172 offset:29696
    s_add_u32 m0, s20, 4096
    s_add_u32 s16, s92, 6
    s_sub_u32 s90, s16, 28
    s_cselect_b32 s16, s16, s90
    s_lshl_b32 s16, s16, 16
    s_add_u32 s16, s16, s33
    buffer_load_dwordx4 v19, s[68:71], s16 offen lds
    buffer_load_dwordx4 v20, s[68:71], s16 offen offset:1024 lds
    s_waitcnt vmcnt(8)
    ds_read_b64_tr_b16 a[168:169], v23 offset:0
    ds_read_b64_tr_b16 a[170:171], v23 offset:1024
    ds_read_b64_tr_b16 a[172:173], v24 offset:0
    ds_read_b64_tr_b16 a[174:175], v24 offset:1024
    ds_read_b128 v[68:71], v172 offset:30720
    ds_read_b128 v[72:75], v172 offset:31744
    ds_read_b128 v[76:79], v173 offset:32768
    ds_read_b128 v[80:83], v173 offset:33792
    ds_read_b128 v[84:87], v173 offset:34816
    ds_read_b128 v[88:91], v173 offset:35840
    ds_read_b128 v[92:95], v174 offset:36864
    ds_read_b128 v[96:99], v174 offset:37888
    ds_read_b128 v[100:103], v174 offset:38912
    ds_read_b128 v[104:107], v174 offset:39936
    v_accvgpr_read_b32 v44, a192
    v_accvgpr_read_b32 v45, a193
    v_accvgpr_read_b32 v46, a194
    v_accvgpr_read_b32 v47, a195
    v_accvgpr_read_b32 v48, a196
    v_accvgpr_read_b32 v49, a197
    v_accvgpr_read_b32 v50, a198
    v_accvgpr_read_b32 v51, a199
    v_accvgpr_read_b32 v52, a200
    v_accvgpr_read_b32 v53, a201
    v_accvgpr_read_b32 v54, a202
    v_accvgpr_read_b32 v55, a203
    v_accvgpr_read_b32 v56, a204
    v_accvgpr_read_b32 v57, a205
    v_accvgpr_read_b32 v58, a206
    v_accvgpr_read_b32 v59, a207
    v_pk_add_f32 v[44:45], v[44:45], v[108:109]
    v_pk_add_f32 v[46:47], v[46:47], v[110:111]
    v_pk_add_f32 v[48:49], v[48:49], v[112:113]
    v_pk_add_f32 v[50:51], v[50:51], v[114:115]
    v_pk_add_f32 v[52:53], v[52:53], v[116:117]
    v_pk_add_f32 v[54:55], v[54:55], v[118:119]
    v_pk_add_f32 v[56:57], v[56:57], v[120:121]
    v_pk_add_f32 v[58:59], v[58:59], v[122:123]
    s_waitcnt lgkmcnt(8)
    v_pk_add_f32 v[44:45], v[44:45], v[60:61]
    v_pk_add_f32 v[46:47], v[46:47], v[62:63]
    v_pk_add_f32 v[48:49], v[48:49], v[64:65]
    v_pk_add_f32 v[50:51], v[50:51], v[66:67]
    v_pk_add_f32 v[52:53], v[52:53], v[68:69]
    v_pk_add_f32 v[54:55], v[54:55], v[70:71]
    v_pk_add_f32 v[56:57], v[56:57], v[72:73]
    v_pk_add_f32 v[58:59], v[58:59], v[74:75]
    s_waitcnt lgkmcnt(4)
    v_pk_add_f32 v[44:45], v[44:45], v[76:77]
    v_pk_add_f32 v[46:47], v[46:47], v[78:79]
    s_add_u32 m0, s20, 6144
    s_add_u32 s16, s92, 7
    s_sub_u32 s90, s16, 28
    s_cselect_b32 s16, s16, s90
    s_lshl_b32 s16, s16, 16
    s_add_u32 s16, s16, s33
    buffer_load_dwordx4 v19, s[68:71], s16 offen lds
    buffer_load_dwordx4 v20, s[68:71], s16 offen offset:1024 lds
    s_waitcnt vmcnt(8)
    ds_read_b64_tr_b16 a[72:73], v23 offset:2048
    ds_read_b64_tr_b16 a[74:75], v23 offset:3072
    ds_read_b64_tr_b16 a[76:77], v24 offset:2048
    ds_read_b64_tr_b16 a[78:79], v24 offset:3072
    v_pk_add_f32 v[48:49], v[48:49], v[80:81]
    v_pk_add_f32 v[50:51], v[50:51], v[82:83]
    v_pk_add_f32 v[52:53], v[52:53], v[84:85]
    v_pk_add_f32 v[54:55], v[54:55], v[86:87]
    v_pk_add_f32 v[56:57], v[56:57], v[88:89]
    v_pk_add_f32 v[58:59], v[58:59], v[90:91]
    s_waitcnt lgkmcnt(4)
    v_pk_add_f32 v[44:45], v[44:45], v[92:93]
    v_pk_add_f32 v[46:47], v[46:47], v[94:95]
    v_pk_add_f32 v[48:49], v[48:49], v[96:97]
    v_pk_add_f32 v[50:51], v[50:51], v[98:99]
    v_pk_add_f32 v[52:53], v[52:53], v[100:101]
    v_pk_add_f32 v[54:55], v[54:55], v[102:103]
    v_pk_add_f32 v[56:57], v[56:57], v[104:105]
    v_pk_add_f32 v[58:59], v[58:59], v[106:107]
    v_pk_mul_f32 v[124:125], v[44:45], v[44:45]
    v_pk_mul_f32 v[126:127], v[46:47], v[46:47]
    v_pk_mul_f32 v[128:129], v[48:49], v[48:49]
    v_pk_mul_f32 v[130:131], v[50:51], v[50:51]
    v_pk_mul_f32 v[132:133], v[52:53], v[52:53]
    v_pk_mul_f32 v[134:135], v[54:55], v[54:55]
    v_pk_mul_f32 v[136:137], v[56:57], v[56:57]
    v_pk_mul_f32 v[138:139], v[58:59], v[58:59]
    v_pk_fma_f32 v[124:125], v[124:125], s[36:37], v[140:141] op_sel_hi:[1,1,0]
    v_pk_fma_f32 v[126:127], v[126:127], s[36:37], v[140:141] op_sel_hi:[1,1,0]
    v_pk_fma_f32 v[128:129], v[128:129], s[36:37], v[140:141] op_sel_hi:[1,1,0]
    v_pk_fma_f32 v[130:131], v[130:131], s[36:37], v[140:141] op_sel_hi:[1,1,0]
    v_pk_fma_f32 v[132:133], v[132:133], s[36:37], v[140:141] op_sel_hi:[1,1,0]
    v_pk_fma_f32 v[134:135], v[134:135], s[36:37], v[140:141] op_sel_hi:[1,1,0]
    v_pk_fma_f32 v[136:137], v[136:137], s[36:37], v[140:141] op_sel_hi:[1,1,0]
    v_pk_fma_f32 v[138:139], v[138:139], s[36:37], v[140:141] op_sel_hi:[1,1,0]
    v_pk_mul_f32 v[124:125], v[124:125], v[44:45]
    v_pk_mul_f32 v[126:127], v[126:127], v[46:47]
    v_pk_mul_f32 v[128:129], v[128:129], v[48:49]
    v_pk_mul_f32 v[130:131], v[130:131], v[50:51]
    v_pk_mul_f32 v[132:133], v[132:133], v[52:53]
    v_pk_mul_f32 v[134:135], v[134:135], v[54:55]
    v_pk_mul_f32 v[136:137], v[136:137], v[56:57]
    v_pk_mul_f32 v[138:139], v[138:139], v[58:59]
    v_exp_f32 v124, v124
    v_exp_f32 v125, v125
    v_exp_f32 v126, v126
    v_exp_f32 v127, v127
    v_exp_f32 v128, v128
    s_add_u32 m0, s20, 8192
    s_add_u32 s16, s92, 8
    s_sub_u32 s90, s16, 28
    s_cselect_b32 s16, s16, s90
    s_lshl_b32 s16, s16, 16
    s_add_u32 s16, s16, s33
    buffer_load_dwordx4 v19, s[68:71], s16 offen lds
    buffer_load_dwordx4 v20, s[68:71], s16 offen offset:1024 lds
    s_waitcnt vmcnt(8)
    ds_read_b64_tr_b16 a[176:177], v23 offset:24576
    ds_read_b64_tr_b16 a[178:179], v23 offset:25600
    ds_read_b64_tr_b16 a[180:181], v24 offset:24576
    ds_read_b64_tr_b16 a[182:183], v24 offset:25600
    v_exp_f32 v129, v129
    v_exp_f32 v130, v130
    v_exp_f32 v131, v131
    v_exp_f32 v132, v132
    v_exp_f32 v133, v133
    v_exp_f32 v134, v134
    v_exp_f32 v135, v135
    v_exp_f32 v136, v136
    v_exp_f32 v137, v137
    v_exp_f32 v138, v138
    v_exp_f32 v139, v139
    v_pk_add_f32 v[124:125], v[124:125], 1.0 op_sel_hi:[1,0]
    v_pk_add_f32 v[126:127], v[126:127], 1.0 op_sel_hi:[1,0]
    v_pk_add_f32 v[128:129], v[128:129], 1.0 op_sel_hi:[1,0]
    v_pk_add_f32 v[130:131], v[130:131], 1.0 op_sel_hi:[1,0]
    v_pk_add_f32 v[132:133], v[132:133], 1.0 op_sel_hi:[1,0]
    v_pk_add_f32 v[134:135], v[134:135], 1.0 op_sel_hi:[1,0]
    v_pk_add_f32 v[136:137], v[136:137], 1.0 op_sel_hi:[1,0]
    v_pk_add_f32 v[138:139], v[138:139], 1.0 op_sel_hi:[1,0]
    v_rcp_f32 v124, v124
    v_rcp_f32 v125, v125
    v_rcp_f32 v126, v126
    v_rcp_f32 v127, v127
    v_rcp_f32 v128, v128
    v_rcp_f32 v129, v129
    v_rcp_f32 v130, v130
    v_rcp_f32 v131, v131
    v_pk_mul_f32 v[44:45], v[44:45], v[124:125]
    v_pk_mul_f32 v[46:47], v[46:47], v[126:127]
    v_pk_mul_f32 v[48:49], v[48:49], v[128:129]
    v_pk_mul_f32 v[50:51], v[50:51], v[130:131]
    v_cvt_pk_bf16_f32 v108, v44, v45
    v_cvt_pk_bf16_f32 v109, v46, v47
    v_cvt_pk_bf16_f32 v110, v48, v49
    v_cvt_pk_bf16_f32 v111, v50, v51
    buffer_store_dwordx4 v[108:111], v6, s[84:87], s15 offen offset:0 sc1
    v_rcp_f32 v132, v132
    v_rcp_f32 v133, v133
    v_rcp_f32 v134, v134
    v_rcp_f32 v135, v135
    v_rcp_f32 v136, v136
    v_rcp_f32 v137, v137
    v_rcp_f32 v138, v138
    v_rcp_f32 v139, v139
    v_pk_mul_f32 v[52:53], v[52:53], v[132:133]
    v_pk_mul_f32 v[54:55], v[54:55], v[134:135]
    v_pk_mul_f32 v[56:57], v[56:57], v[136:137]
    v_pk_mul_f32 v[58:59], v[58:59], v[138:139]
    v_cvt_pk_bf16_f32 v112, v52, v53
    v_cvt_pk_bf16_f32 v113, v54, v55
    v_cvt_pk_bf16_f32 v114, v56, v57
    v_cvt_pk_bf16_f32 v115, v58, v59
    buffer_store_dwordx4 v[112:115], v6, s[84:87], s15 offen offset:2048 sc1
    s_add_u32 m0, s20, 16384
    s_add_u32 s16, s92, 9
    s_sub_u32 s90, s16, 28
    s_cselect_b32 s16, s16, s90
    s_lshl_b32 s16, s16, 16
    s_add_u32 s16, s16, s33
    buffer_load_dwordx4 v19, s[68:71], s16 offen lds
    buffer_load_dwordx4 v20, s[68:71], s16 offen offset:1024 lds
    s_waitcnt vmcnt(10)
    ds_read_b64_tr_b16 a[88:89], v23 offset:26624
    ds_read_b64_tr_b16 a[90:91], v23 offset:27648
    ds_read_b64_tr_b16 a[92:93], v24 offset:26624
    ds_read_b64_tr_b16 a[94:95], v24 offset:27648
    s_add_u32 m0, s20, 18432
    s_add_u32 s16, s92, 10
    s_sub_u32 s90, s16, 28
    s_cselect_b32 s16, s16, s90
    s_lshl_b32 s16, s16, 16
    s_add_u32 s16, s16, s33
    buffer_load_dwordx4 v19, s[68:71], s16 offen lds
    buffer_load_dwordx4 v20, s[68:71], s16 offen offset:1024 lds
    s_waitcnt vmcnt(10)
    ds_read_b64_tr_b16 a[0:1], v23 offset:4096
    ds_read_b64_tr_b16 a[2:3], v23 offset:5120
    ds_read_b64_tr_b16 a[4:5], v24 offset:4096
    ds_read_b64_tr_b16 a[6:7], v24 offset:5120
    s_add_u32 m0, s20, 20480
    s_add_u32 s16, s92, 11
    s_sub_u32 s90, s16, 28
    s_cselect_b32 s16, s16, s90
    s_lshl_b32 s16, s16, 16
    s_add_u32 s16, s16, s33
    buffer_load_dwordx4 v19, s[68:71], s16 offen lds
    buffer_load_dwordx4 v20, s[68:71], s16 offen offset:1024 lds
    s_waitcnt vmcnt(10)
    ds_read_b64_tr_b16 a[104:105], v23 offset:6144
    ds_read_b64_tr_b16 a[106:107], v23 offset:7168
    ds_read_b64_tr_b16 a[108:109], v24 offset:6144
    ds_read_b64_tr_b16 a[110:111], v24 offset:7168
    s_waitcnt vmcnt(6)
    v_mov_b32 v2, s4
    s_mov_b32 exec_hi, 0
    buffer_store_dword v2, v42, s[84:87], s42 offen sc1
    s_mov_b64 exec, -1
    s_sub_u32 s5, s97, 16
    s_cmp_lt_u32 s5, 8
    s_cbranch_scc1 L_ofin
    s_add_u32 m0, s20, 22528
    s_add_u32 s16, s92, 12
    s_sub_u32 s90, s16, 28
    s_cselect_b32 s16, s16, s90
    s_lshl_b32 s16, s16, 16
    s_add_u32 s16, s16, s33
    buffer_load_dwordx4 v19, s[68:71], s16 offen lds
    buffer_load_dwordx4 v20, s[68:71], s16 offen offset:1024 lds
    s_add_u32 m0, s20, 10240
    s_add_u32 s16, s92, 13
    s_sub_u32 s90, s16, 28
    s_cselect_b32 s16, s16, s90
    s_lshl_b32 s16, s16, 16
    s_add_u32 s16, s16, s33
    buffer_load_dwordx4 v19, s[68:71], s16 offen lds
    buffer_load_dwordx4 v20, s[68:71], s16 offen offset:1024 lds
    s_add_u32 m0, s20, 12288
    s_add_u32 s16, s92, 14
    s_sub_u32 s90, s16, 28
    s_cselect_b32 s16, s16, s90
    s_lshl_b32 s16, s16, 16
    s_add_u32 s16, s16, s33
    buffer_load_dwordx4 v19, s[68:71], s16 offen lds
    buffer_load_dwordx4 v20, s[68:71], s16 offen offset:1024 lds
    s_add_u32 m0, s20, 14336
    s_add_u32 s16, s92, 15
    s_sub_u32 s90, s16, 28
    s_cselect_b32 s16, s16, s90
    s_lshl_b32 s16, s16, 16
    s_add_u32 s16, s16, s33
    buffer_load_dwordx4 v19, s[68:71], s16 offen lds
    buffer_load_dwordx4 v20, s[68:71], s16 offen offset:1024 lds
    s_add_u32 m0, s20, 0
    s_add_u32 s16, s92, 16
    s_sub_u32 s90, s16, 28
    s_cselect_b32 s16, s16, s90
    s_lshl_b32 s16, s16, 16
    s_add_u32 s16, s16, s33
    buffer_load_dwordx4 v19, s[68:71], s16 offen lds
    buffer_load_dwordx4 v20, s[68:71], s16 offen offset:1024 lds
    s_waitcnt lgkmcnt(15)
    s_add_u32 m0, s20, 2048
    s_add_u32 s16, s92, 17
    s_sub_u32 s90, s16, 28
    s_cselect_b32 s16, s16, s90
    s_lshl_b32 s16, s16, 16
    s_add_u32 s16, s16, s33
    buffer_load_dwordx4 v19, s[68:71], s16 offen lds
    buffer_load_dwordx4 v20, s[68:71], s16 offen offset:1024 lds
    s_waitcnt lgkmcnt(12)
    s_add_u32 m0, s20, 24576
    s_add_u32 s16, s92, 18
    s_sub_u32 s90, s16, 28
    s_cselect_b32 s16, s16, s90
    s_lshl_b32 s16, s16, 16
    s_add_u32 s16, s16, s33
    buffer_load_dwordx4 v19, s[68:71], s16 offen lds
    buffer_load_dwordx4 v20, s[68:71], s16 offen offset:1024 lds
    s_waitcnt lgkmcnt(8)
    s_add_u32 m0, s20, 26624
    s_add_u32 s16, s92, 19
    s_sub_u32 s90, s16, 28
    s_cselect_b32 s16, s16, s90
    s_lshl_b32 s16, s16, 16
    s_add_u32 s16, s16, s33
    buffer_load_dwordx4 v19, s[68:71], s16 offen lds
    buffer_load_dwordx4 v20, s[68:71], s16 offen offset:1024 lds
    s_waitcnt lgkmcnt(4)
    s_add_u32 m0, s20, 4096
    s_add_u32 s16, s92, 20
    s_sub_u32 s90, s16, 28
    s_cselect_b32 s16, s16, s90
    s_lshl_b32 s16, s16, 16
    s_add_u32 s16, s16, s33
    buffer_load_dwordx4 v19, s[68:71], s16 offen lds
    buffer_load_dwordx4 v20, s[68:71], s16 offen offset:1024 lds
    s_waitcnt lgkmcnt(0)
    s_add_u32 m0, s20, 6144
    s_add_u32 s16, s92, 21
    s_sub_u32 s90, s16, 28
    s_cselect_b32 s16, s16, s90
    s_lshl_b32 s16, s16, 16
    s_add_u32 s16, s16, s33
    buffer_load_dwordx4 v19, s[68:71], s16 offen lds
    buffer_load_dwordx4 v20, s[68:71], s16 offen offset:1024 lds
    ds_read_b64_tr_b16 a[8:9], v23 offset:8192
    ds_read_b64_tr_b16 a[10:11], v23 offset:9216
    ds_read_b64_tr_b16 a[12:13], v24 offset:8192
    ds_read_b64_tr_b16 a[14:15], v24 offset:9216
    s_waitcnt lgkmcnt(0)
    s_add_u32 m0, s20, 8192
    s_add_u32 s16, s92, 22
    s_sub_u32 s90, s16, 28
    s_cselect_b32 s16, s16, s90
    s_lshl_b32 s16, s16, 16
    s_add_u32 s16, s16, s33
    buffer_load_dwordx4 v19, s[68:71], s16 offen lds
    buffer_load_dwordx4 v20, s[68:71], s16 offen offset:1024 lds
    s_waitcnt vmcnt(27)
    ds_read_b64_tr_b16 a[184:185], v23 offset:16384
    ds_read_b64_tr_b16 a[186:187], v23 offset:17408
    ds_read_b64_tr_b16 a[188:189], v24 offset:16384
    ds_read_b64_tr_b16 a[190:191], v24 offset:17408
    s_waitcnt lgkmcnt(0)
    s_add_u32 m0, s20, 16384
    s_add_u32 s16, s92, 23
    s_sub_u32 s90, s16, 28
    s_cselect_b32 s16, s16, s90
    s_lshl_b32 s16, s16, 16
    s_add_u32 s16, s16, s33
    buffer_load_dwordx4 v19, s[68:71], s16 offen lds
    buffer_load_dwordx4 v20, s[68:71], s16 offen offset:1024 lds
    s_waitcnt vmcnt(27)
    ds_read_b64_tr_b16 a[16:17], v23 offset:18432
    ds_read_b64_tr_b16 a[18:19], v23 offset:19456
    ds_read_b64_tr_b16 a[20:21], v24 offset:18432
    ds_read_b64_tr_b16 a[22:23], v24 offset:19456
    s_waitcnt lgkmcnt(0)
    s_add_u32 m0, s20, 18432
    s_add_u32 s16, s92, 24
    s_sub_u32 s90, s16, 28
    s_cselect_b32 s16, s16, s90
    s_lshl_b32 s16, s16, 16
    s_add_u32 s16, s16, s33
    buffer_load_dwordx4 v19, s[68:71], s16 offen lds
    buffer_load_dwordx4 v20, s[68:71], s16 offen offset:1024 lds
    s_waitcnt vmcnt(27)
    ds_read_b64_tr_b16 a[48:49], v23 offset:20480
    ds_read_b64_tr_b16 a[50:51], v23 offset:21504
    ds_read_b64_tr_b16 a[52:53], v24 offset:20480
    ds_read_b64_tr_b16 a[54:55], v24 offset:21504
    s_waitcnt lgkmcnt(0)
    s_add_u32 m0, s20, 20480
    s_add_u32 s16, s92, 25
    s_sub_u32 s90, s16, 28
    s_cselect_b32 s16, s16, s90
    s_lshl_b32 s16, s16, 16
    s_add_u32 s16, s16, s33
    buffer_load_dwordx4 v19, s[68:71], s16 offen lds
    buffer_load_dwordx4 v20, s[68:71], s16 offen offset:1024 lds
L_p3:
    s_waitcnt lgkmcnt(0)
    s_lshl_b32 s5, s28, 5
    s_mul_i32 s6, s3, 7
    s_add_u32 s5, s5, s6
    s_lshl_b32 s5, s5, 9
    s_add_u32 s31, s5, 0xc40000
    v_min_u32 v9, 3456, v7
    buffer_load_dword v8, v9, s[84:87], s31 offen sc1
    s_waitcnt vmcnt(27)
    ds_read_b64_tr_b16 a[24:25], v23 offset:22528
    ds_read_b64_tr_b16 a[26:27], v23 offset:23552
    ds_read_b64_tr_b16 a[28:29], v24 offset:22528
    ds_read_b64_tr_b16 a[30:31], v24 offset:23552
    s_waitcnt lgkmcnt(0)
    s_add_u32 m0, s20, 22528
    s_add_u32 s16, s92, 26
    s_sub_u32 s90, s16, 28
    s_cselect_b32 s16, s16, s90
    s_lshl_b32 s16, s16, 16
    s_add_u32 s16, s16, s33
    buffer_load_dwordx4 v19, s[68:71], s16 offen lds
    buffer_load_dwordx4 v20, s[68:71], s16 offen offset:1024 lds
    s_waitcnt vmcnt(27)
    ds_read_b64_tr_b16 a[64:65], v23 offset:10240
    ds_read_b64_tr_b16 a[66:67], v23 offset:11264
    ds_read_b64_tr_b16 a[68:69], v24 offset:10240
    ds_read_b64_tr_b16 a[70:71], v24 offset:11264
    s_waitcnt lgkmcnt(0)
    s_add_u32 m0, s20, 10240
    s_add_u32 s16, s92, 27
    s_sub_u32 s90, s16, 28
    s_cselect_b32 s16, s16, s90
    s_lshl_b32 s16, s16, 16
    s_add_u32 s16, s16, s33
    buffer_load_dwordx4 v19, s[68:71], s16 offen lds
    buffer_load_dwordx4 v20, s[68:71], s16 offen offset:1024 lds
    s_waitcnt vmcnt(27)
    ds_read_b64_tr_b16 a[96:97], v23 offset:12288
    ds_read_b64_tr_b16 a[98:99], v23 offset:13312
    ds_read_b64_tr_b16 a[100:101], v24 offset:12288
    ds_read_b64_tr_b16 a[102:103], v24 offset:13312
    s_waitcnt lgkmcnt(0)
    s_add_u32 m0, s20, 12288
    s_add_u32 s16, s93, 0
    s_and_b32 s16, s16, 7
    s_lshl_b32 s16, s16, 14
    s_add_u32 s16, s16, s35
    buffer_load_dwordx4 v21, s[76:79], s16 offen lds
    buffer_load_dwordx4 v22, s[76:79], s16 offen offset:1024 lds
    s_waitcnt vmcnt(27)
    ds_read_b64_tr_b16 a[80:81], v23 offset:14336
    ds_read_b64_tr_b16 a[82:83], v23 offset:15360
    ds_read_b64_tr_b16 a[84:85], v24 offset:14336
    ds_read_b64_tr_b16 a[86:87], v24 offset:15360
    s_waitcnt lgkmcnt(0)
    s_add_u32 m0, s20, 14336
    s_add_u32 s16, s93, 1
    s_and_b32 s16, s16, 7
    s_lshl_b32 s16, s16, 14
    s_add_u32 s16, s16, s35
    buffer_load_dwordx4 v21, s[76:79], s16 offen lds
    buffer_load_dwordx4 v22, s[76:79], s16 offen offset:1024 lds
    s_waitcnt vmcnt(27)
    ds_read_b64_tr_b16 a[144:145], v23 offset:0
    ds_read_b64_tr_b16 a[146:147], v23 offset:1024
    ds_read_b64_tr_b16 a[148:149], v24 offset:0
    ds_read_b64_tr_b16 a[150:151], v24 offset:1024
    s_waitcnt lgkmcnt(0)
    s_add_u32 m0, s20, 0
    s_add_u32 s16, s93, 2
    s_and_b32 s16, s16, 7
    s_lshl_b32 s16, s16, 14
    s_add_u32 s16, s16, s35
    buffer_load_dwordx4 v21, s[76:79], s16 offen lds
    buffer_load_dwordx4 v22, s[76:79], s16 offen offset:1024 lds
    s_lshl_b32 s5, s3, 6
    s_add_u32 s5, s5, s29
    s_lshl_b32 s5, s5, 7
    s_add_u32 s30, s5, 0xc60000
    v_and_b32 v5, 1, v1
    v_lshlrev_b32 v5, 12, v5
    s_xor_b32 s5, s3, 1
    s_mul_i32 s5, s5, 40960
    v_add_u32 v172, s5, v6
    s_xor_b32 s5, s3, 2
    s_mul_i32 s5, s5, 40960
    v_add_u32 v173, s5, v6
    s_xor_b32 s5, s3, 3
    s_mul_i32 s5, s5, 40960
    v_add_u32 v174, s5, v6
    v_and_b32 v2, 31, v1
    v_lshrrev_b32 v175, 5, v1
    v_lshlrev_b32 v175, 4, v175
    v_lshl_add_u32 v175, v2, 10, v175
    s_lshl_b32 s5, s29, 16
    s_lshl_b32 s6, s9, 15
    s_add_u32 s5, s5, s6
    s_lshl_b32 s6, s28, 7
    s_add_u32 s5, s5, s6
    s_lshl_b32 s6, s10, 6
    s_add_u32 s14, s5, s6
    s_waitcnt vmcnt(10)
    v_cmp_ne_u32 vcc, s4, v8
    s_mov_b32 s19, 0x40000
    s_cmp_lg_u64 vcc, 0
    s_cbranch_scc1 L_spin3
L_go3:
    s_add_u32 s17, s92, 0
    s_sub_u32 s90, s17, 28
    s_cselect_b32 s17, s17, s90
    s_lshl_b32 s17, s17, 11
    s_add_u32 s17, s17, s32
    buffer_load_dwordx4 a[112:115], v17, s[84:87], s17 offen sc1
    buffer_load_dwordx4 a[116:119], v18, s[84:87], s17 offen sc1
    s_add_u32 s17, s92, 1
    s_sub_u32 s90, s17, 28
    s_cselect_b32 s17, s17, s90
    s_lshl_b32 s17, s17, 11
    s_add_u32 s17, s17, s32
    buffer_load_dwordx4 a[32:35], v17, s[84:87], s17 offen sc1
    buffer_load_dwordx4 a[36:39], v18, s[84:87], s17 offen sc1
    s_add_u32 s17, s92, 2
    s_sub_u32 s90, s17, 28
    s_cselect_b32 s17, s17, s90
    s_lshl_b32 s17, s17, 11
    s_add_u32 s17, s17, s32
    buffer_load_dwordx4 a[120:123], v17, s[84:87], s17 offen sc1
    buffer_load_dwordx4 a[124:127], v18, s[84:87], s17 offen sc1
    s_add_u32 s17, s92, 3
    s_sub_u32 s90, s17, 28
    s_cselect_b32 s17, s17, s90
    s_lshl_b32 s17, s17, 11
    s_add_u32 s17, s17, s32
    buffer_load_dwordx4 a[152:155], v17, s[84:87], s17 offen sc1
    buffer_load_dwordx4 a[156:159], v18, s[84:87], s17 offen sc1
    s_add_u32 s17, s92, 4
    s_sub_u32 s90, s17, 28
    s_cselect_b32 s17, s17, s90
    s_lshl_b32 s17, s17, 11
    s_add_u32 s17, s17, s32
    buffer_load_dwordx4 a[128:131], v17, s[84:87], s17 offen sc1
    buffer_load_dwordx4 a[132:135], v18, s[84:87], s17 offen sc1
    s_add_u32 s17, s92, 5
    s_sub_u32 s90, s17, 28
    s_cselect_b32 s17, s17, s90
    s_lshl_b32 s17, s17, 11
    s_add_u32 s17, s17, s32
    buffer_load_dwordx4 a[40:43], v17, s[84:87], s17 offen sc1
    buffer_load_dwordx4 a[44:47], v18, s[84:87], s17 offen sc1
    v_and_b32 v2, 31, v1
    v_lshlrev_b32 v3, 2, v2
    s_lshl_b32 s5, s29, 8
    s_lshl_b32 s6, s9, 7
    s_add_u32 s5, s5, 0xc00000
    s_xor_b32 s7, s6, 128
    s_add_u32 s6, s6, s5
    s_add_u32 s7, s7, s5
    buffer_load_dword v36, v3, s[84:87], s6 offen sc1
    buffer_load_dword v37, v3, s[84:87], s7 offen sc1
    s_waitcnt vmcnt(12)
    v_mfma_f32_32x32x16_bf16 v[44:59], a[112:115], a[160:163], 0
    s_add_u32 s17, s92, 6
    s_sub_u32 s90, s17, 28
    s_cselect_b32 s17, s17, s90
    s_lshl_b32 s17, s17, 11
    v_mfma_f32_32x32x16_bf16 v[60:75], a[112:115], a[164:167], 0
    s_add_u32 s17, s17, s32
    buffer_load_dwordx4 a[136:139], v17, s[84:87], s17 offen sc1
    v_mfma_f32_32x32x16_bf16 v[76:91], a[116:119], a[160:163], 0
    buffer_load_dwordx4 a[140:143], v18, s[84:87], s17 offen sc1
    ds_read_b64_tr_b16 a[192:193], v23 offset:2048
    v_mfma_f32_32x32x16_bf16 v[92:107], a[116:119], a[164:167], 0
    ds_read_b64_tr_b16 a[194:195], v23 offset:3072
    ds_read_b64_tr_b16 a[196:197], v24 offset:2048
    ds_read_b64_tr_b16 a[198:199], v24 offset:3072
    s_waitcnt vmcnt(12)
    v_mfma_f32_32x32x16_bf16 v[44:59], a[32:35], a[56:59], v[44:59]
    s_add_u32 s17, s92, 7
    s_sub_u32 s90, s17, 28
    s_cselect_b32 s17, s17, s90
    s_lshl_b32 s17, s17, 11
    s_add_u32 s17, s17, s32
    buffer_load_dwordx4 a[200:203], v17, s[84:87], s17 offen sc1
    v_mfma_f32_32x32x16_bf16 v[60:75], a[32:35], a[60:63], v[60:75]
    buffer_load_dwordx4 a[204:207], v18, s[84:87], s17 offen sc1
    s_waitcnt lgkmcnt(0)
    s_add_u32 m0, s20, 2048
    s_add_u32 s16, s93, 3
    s_and_b32 s16, s16, 7
    v_mfma_f32_32x32x16_bf16 v[76:91], a[36:39], a[56:59], v[76:91]
    s_lshl_b32 s16, s16, 14
    s_add_u32 s16, s16, s35
    buffer_load_dwordx4 v21, s[76:79], s16 offen lds
    buffer_load_dwordx4 v22, s[76:79], s16 offen offset:1024 lds
    v_mfma_f32_32x32x16_bf16 v[92:107], a[36:39], a[60:63], v[92:107]
    ds_read_b64_tr_b16 a[208:209], v23 offset:24576
    ds_read_b64_tr_b16 a[210:211], v23 offset:25600
    ds_read_b64_tr_b16 a[212:213], v24 offset:24576
    ds_read_b64_tr_b16 a[214:215], v24 offset:25600
    s_waitcnt vmcnt(14)
    v_mfma_f32_32x32x16_bf16 v[44:59], a[120:123], a[168:171], v[44:59]
    s_add_u32 s17, s92, 8
    s_sub_u32 s90, s17, 28
    s_cselect_b32 s17, s17, s90
    s_lshl_b32 s17, s17, 11
    v_mfma_f32_32x32x16_bf16 v[60:75], a[120:123], a[172:175], v[60:75]
    s_add_u32 s17, s17, s32
    buffer_load_dwordx4 a[216:219], v17, s[84:87], s17 offen sc1
    v_mfma_f32_32x32x16_bf16 v[76:91], a[124:127], a[168:171], v[76:91]
    buffer_load_dwordx4 a[220:223], v18, s[84:87], s17 offen sc1
    ds_read_b64_tr_b16 a[224:225], v23 offset:26624
    v_mfma_f32_32x32x16_bf16 v[92:107], a[124:127], a[172:175], v[92:107]
    ds_read_b64_tr_b16 a[226:227], v23 offset:27648
    ds_read_b64_tr_b16 a[228:229], v24 offset:26624
    ds_read_b64_tr_b16 a[230:231], v24 offset:27648
    s_waitcnt vmcnt(14)
    v_mfma_f32_32x32x16_bf16 v[44:59], a[152:155], a[72:75], v[44:59]
    s_add_u32 s17, s92, 9
    s_sub_u32 s90, s17, 28
    s_cselect_b32 s17, s17, s90
    s_lshl_b32 s17, s17, 11
    s_add_u32 s17, s17, s32
    buffer_load_dwordx4 a[232:235], v17, s[84:87], s17 offen sc1
    v_mfma_f32_32x32x16_bf16 v[60:75], a[152:155], a[76:79], v[60:75]
    buffer_load_dwordx4 a[236:239], v18, s[84:87], s17 offen sc1
    s_waitcnt lgkmcnt(4)
    s_add_u32 m0, s20, 24576
    s_add_u32 s16, s93, 4
    s_and_b32 s16, s16, 7
    v_mfma_f32_32x32x16_bf16 v[76:91], a[156:159], a[72:75], v[76:91]
    s_lshl_b32 s16, s16, 14
    s_add_u32 s16, s16, s35
    buffer_load_dwordx4 v21, s[76:79], s16 offen lds
    buffer_load_dwordx4 v22, s[76:79], s16 offen offset:1024 lds
    v_mfma_f32_32x32x16_bf16 v[92:107], a[156:159], a[76:79], v[92:107]
    ds_read_b64_tr_b16 a[240:241], v23 offset:4096
    ds_read_b64_tr_b16 a[242:243], v23 offset:5120
    ds_read_b64_tr_b16 a[244:245], v24 offset:4096
    ds_read_b64_tr_b16 a[246:247], v24 offset:5120
    s_barrier
    s_waitcnt vmcnt(16)
    v_mfma_f32_32x32x16_bf16 v[44:59], a[128:131], a[176:179], v[44:59]
    s_add_u32 s17, s92, 10
    s_sub_u32 s90, s17, 28
    s_cselect_b32 s17, s17, s90
    s_lshl_b32 s17, s17, 11
    v_mfma_f32_32x32x16_bf16 v[60:75], a[128:131], a[180:183], v[60:75]
    s_add_u32 s17, s17, s32
    buffer_load_dwordx4 a[248:251], v17, s[84:87], s17 offen sc1
    v_mfma_f32_32x32x16_bf16 v[76:91], a[132:135], a[176:179], v[76:91]
    buffer_load_dwordx4 a[252:255], v18, s[84:87], s17 offen sc1
    ds_read_b64_tr_b16 a[160:161], v23 offset:6144
    v_mfma_f32_32x32x16_bf16 v[92:107], a[132:135], a[180:183], v[92:107]
    ds_read_b64_tr_b16 a[162:163], v23 offset:7168
    ds_read_b64_tr_b16 a[164:165], v24 offset:6144
    ds_read_b64_tr_b16 a[166:167], v24 offset:7168
    s_waitcnt vmcnt(16)
    v_mfma_f32_32x32x16_bf16 v[44:59], a[40:43], a[88:91], v[44:59]
    s_add_u32 s17, s92, 11
    s_sub_u32 s90, s17, 28
    s_cselect_b32 s17, s17, s90
    s_lshl_b32 s17, s17, 11
    s_add_u32 s17, s17, s32
    buffer_load_dwordx4 a[112:115], v17, s[84:87], s17 offen sc1
    v_mfma_f32_32x32x16_bf16 v[60:75], a[40:43], a[92:95], v[60:75]
    buffer_load_dwordx4 a[116:119], v18, s[84:87], s17 offen sc1
    s_waitcnt lgkmcnt(8)
    s_add_u32 m0, s20, 26624
    s_add_u32 s16, s93, 5
    s_and_b32 s16, s16, 7
    v_mfma_f32_32x32x16_bf16 v[76:91], a[44:47], a[88:91], v[76:91]
    s_lshl_b32 s16, s16, 14
    s_add_u32 s16, s16, s35
    buffer_load_dwordx4 v21, s[76:79], s16 offen lds
    buffer_load_dwordx4 v22, s[76:79], s16 offen offset:1024 lds
    v_mfma_f32_32x32x16_bf16 v[92:107], a[44:47], a[92:95], v[92:107]
    ds_read_b64_tr_b16 a[56:57], v23 offset:8192
    ds_read_b64_tr_b16 a[58:59], v23 offset:9216
    ds_read_b64_tr_b16 a[60:61], v24 offset:8192
    ds_read_b64_tr_b16 a[62:63], v24 offset:9216
    s_waitcnt vmcnt(16)
    v_mfma_f32_32x32x16_bf16 v[44:59], a[136:139], a[0:3], v[44:59]
    s_add_u32 s17, s92, 12
    s_sub_u32 s90, s17, 28
    s_cselect_b32 s17, s17, s90
    s_lshl_b32 s17, s17, 11
    v_mfma_f32_32x32x16_bf16 v[60:75], a[136:139], a[4:7], v[60:75]
    s_add_u32 s17, s17, s32
    buffer_load_dwordx4 a[32:35], v17, s[84:87], s17 offen sc1
    v_mfma_f32_32x32x16_bf16 v[76:91], a[140:143], a[0:3], v[76:91]
    buffer_load_dwordx4 a[36:39], v18, s[84:87], s17 offen sc1
    ds_read_b64_tr_b16 a[168:169], v23 offset:16384
    v_mfma_f32_32x32x16_bf16 v[92:107], a[140:143], a[4:7], v[92:107]
    ds_read_b64_tr_b16 a[170:171], v23 offset:17408
    ds_read_b64_tr_b16 a[172:173], v24 offset:16384
    ds_read_b64_tr_b16 a[174:175], v24 offset:17408
    s_waitcnt vmcnt(16)
    v_mfma_f32_32x32x16_bf16 v[44:59], a[200:203], a[104:107], v[44:59]
    s_add_u32 s17, s92, 13
    s_sub_u32 s90, s17, 28
    s_cselect_b32 s17, s17, s90
    s_lshl_b32 s17, s17, 11
    s_add_u32 s17, s17, s32
    buffer_load_dwordx4 a[120:123], v17, s[84:87], s17 offen sc1
    v_mfma_f32_32x32x16_bf16 v[60:75], a[200:203], a[108:111], v[60:75]
    buffer_load_dwordx4 a[124:127], v18, s[84:87], s17 offen sc1
    s_waitcnt lgkmcnt(12)
    s_add_u32 m0, s20, 4096
    s_add_u32 s16, s93, 6
    s_and_b32 s16, s16, 7
    v_mfma_f32_32x32x16_bf16 v[76:91], a[204:207], a[104:107], v[76:91]
    s_lshl_b32 s16, s16, 14
    s_add_u32 s16, s16, s35
    buffer_load_dwordx4 v21, s[76:79], s16 offen lds
    buffer_load_dwordx4 v22, s[76:79], s16 offen offset:1024 lds
    v_mfma_f32_32x32x16_bf16 v[92:107], a[204:207], a[108:111], v[92:107]
    ds_read_b64_tr_b16 a[72:73], v23 offset:18432
    ds_read_b64_tr_b16 a[74:75], v23 offset:19456
    ds_read_b64_tr_b16 a[76:77], v24 offset:18432
    ds_read_b64_tr_b16 a[78:79], v24 offset:19456
    s_waitcnt vmcnt(16)
    v_mfma_f32_32x32x16_bf16 v[44:59], a[216:219], a[8:11], v[44:59]
    s_add_u32 s17, s92, 14
    s_sub_u32 s90, s17, 28
    s_cselect_b32 s17, s17, s90
    s_lshl_b32 s17, s17, 11
    v_mfma_f32_32x32x16_bf16 v[60:75], a[216:219], a[12:15], v[60:75]
    s_add_u32 s17, s17, s32
    buffer_load_dwordx4 a[152:155], v17, s[84:87], s17 offen sc1
    v_mfma_f32_32x32x16_bf16 v[76:91], a[220:223], a[8:11], v[76:91]
    buffer_load_dwordx4 a[156:159], v18, s[84:87], s17 offen sc1
    ds_read_b64_tr_b16 a[176:177], v23 offset:20480
    v_mfma_f32_32x32x16_bf16 v[92:107], a[220:223], a[12:15], v[92:107]
    ds_read_b64_tr_b16 a[178:179], v23 offset:21504
    ds_read_b64_tr_b16 a[180:181], v24 offset:20480
    ds_read_b64_tr_b16 a[182:183], v24 offset:21504
    s_waitcnt vmcnt(16)
    v_mfma_f32_32x32x16_bf16 v[44:59], a[232:235], a[184:187], v[44:59]
    s_add_u32 s17, s92, 15
    s_sub_u32 s90, s17, 28
    s_cselect_b32 s17, s17, s90
    s_lshl_b32 s17, s17, 11
    s_add_u32 s17, s17, s32
    buffer_load_dwordx4 a[128:131], v17, s[84:87], s17 offen sc1
    v_mfma_f32_32x32x16_bf16 v[60:75], a[232:235], a[188:191], v[60:75]
    buffer_load_dwordx4 a[132:135], v18, s[84:87], s17 offen sc1
    s_waitcnt lgkmcnt(15)
    s_add_u32 m0, s20, 6144
    s_add_u32 s16, s93, 7
    s_and_b32 s16, s16, 7
    v_mfma_f32_32x32x16_bf16 v[76:91], a[236:239], a[184:187], v[76:91]
    s_lshl_b32 s16, s16, 14
    s_add_u32 s16, s16, s35
    buffer_load_dwordx4 v21, s[76:79], s16 offen lds
    buffer_load_dwordx4 v22, s[76:79], s16 offen offset:1024 lds
    v_mfma_f32_32x32x16_bf16 v[92:107], a[236:239], a[188:191], v[92:107]
    ds_read_b64_tr_b16 a[88:89], v23 offset:22528
    ds_read_b64_tr_b16 a[90:91], v23 offset:23552
    ds_read_b64_tr_b16 a[92:93], v24 offset:22528
    ds_read_b64_tr_b16 a[94:95], v24 offset:23552
    s_waitcnt vmcnt(16)
    v_mfma_f32_32x32x16_bf16 v[44:59], a[248:251], a[16:19], v[44:59]
    s_add_u32 s17, s92, 16
    s_sub_u32 s90, s17, 28
    s_cselect_b32 s17, s17, s90
    s_lshl_b32 s17, s17, 11
    v_mfma_f32_32x32x16_bf16 v[60:75], a[248:251], a[20:23], v[60:75]
    s_add_u32 s17, s17, s32
    buffer_load_dwordx4 a[40:43], v17, s[84:87], s17 offen sc1
    v_mfma_f32_32x32x16_bf16 v[76:91], a[252:255], a[16:19], v[76:91]
    buffer_load_dwordx4 a[44:47], v18, s[84:87], s17 offen sc1
    ds_read_b64_tr_b16 a[0:1], v23 offset:10240
    v_mfma_f32_32x32x16_bf16 v[92:107], a[252:255], a[20:23], v[92:107]
    ds_read_b64_tr_b16 a[2:3], v23 offset:11264
    ds_read_b64_tr_b16 a[4:5], v24 offset:10240
    ds_read_b64_tr_b16 a[6:7], v24 offset:11264
    s_waitcnt vmcnt(16)
    v_mfma_f32_32x32x16_bf16 v[44:59], a[112:115], a[48:51], v[44:59]
    s_add_u32 s17, s92, 17
    s_sub_u32 s90, s17, 28
    s_cselect_b32 s17, s17, s90
    s_lshl_b32 s17, s17, 11
    v_mfma_f32_32x32x16_bf16 v[60:75], a[112:115], a[52:55], v[60:75]
    s_add_u32 s17, s17, s32
    buffer_load_dwordx4 a[136:139], v17, s[84:87], s17 offen sc1
    v_mfma_f32_32x32x16_bf16 v[76:91], a[116:119], a[48:51], v[76:91]
    buffer_load_dwordx4 a[140:143], v18, s[84:87], s17 offen sc1
    ds_read_b64_tr_b16 a[104:105], v25 offset:12288
    v_mfma_f32_32x32x16_bf16 v[92:107], a[116:119], a[52:55], v[92:107]
    ds_read_b64_tr_b16 a[106:107], v25 offset:13312
    ds_read_b64_tr_b16 a[108:109], v26 offset:12288
    ds_read_b64_tr_b16 a[110:111], v26 offset:13312
    s_waitcnt vmcnt(14)
    v_mfma_f32_32x32x16_bf16 v[44:59], a[32:35], a[24:27], v[44:59]
    s_add_u32 s17, s92, 18
    s_sub_u32 s90, s17, 28
    s_cselect_b32 s17, s17, s90
    s_lshl_b32 s17, s17, 11
    v_mfma_f32_32x32x16_bf16 v[60:75], a[32:35], a[28:31], v[60:75]
    s_add_u32 s17, s17, s32
    buffer_load_dwordx4 a[200:203], v17, s[84:87], s17 offen sc1
    v_mfma_f32_32x32x16_bf16 v[76:91], a[36:39], a[24:27], v[76:91]
    buffer_load_dwordx4 a[204:207], v18, s[84:87], s17 offen sc1
    ds_read_b64_tr_b16 a[8:9], v25 offset:14336
    v_mfma_f32_32x32x16_bf16 v[92:107], a[36:39], a[28:31], v[92:107]
    ds_read_b64_tr_b16 a[10:11], v25 offset:15360
    ds_read_b64_tr_b16 a[12:13], v26 offset:14336
    ds_read_b64_tr_b16 a[14:15], v26 offset:15360
    s_waitcnt vmcnt(14)
    v_mfma_f32_32x32x16_bf16 v[44:59], a[120:123], a[64:67], v[44:59]
    s_add_u32 s17, s92, 19
    s_sub_u32 s90, s17, 28
    s_cselect_b32 s17, s17, s90
    s_lshl_b32 s17, s17, 11
    v_mfma_f32_32x32x16_bf16 v[60:75], a[120:123], a[68:71], v[60:75]
    s_add_u32 s17, s17, s32
    buffer_load_dwordx4 a[216:219], v17, s[84:87], s17 offen sc1
    v_mfma_f32_32x32x16_bf16 v[76:91], a[124:127], a[64:67], v[76:91]
    buffer_load_dwordx4 a[220:223], v18, s[84:87], s17 offen sc1
    ds_read_b64_tr_b16 a[184:185], v25 offset:0
    v_mfma_f32_32x32x16_bf16 v[92:107], a[124:127], a[68:71], v[92:107]
    ds_read_b64_tr_b16 a[186:187], v25 offset:1024
    ds_read_b64_tr_b16 a[188:189], v26 offset:0
    ds_read_b64_tr_b16 a[190:191], v26 offset:1024
    s_waitcnt vmcnt(12)
    v_mfma_f32_32x32x16_bf16 v[44:59], a[152:155], a[96:99], v[44:59]
    s_add_u32 s17, s92, 20
    s_sub_u32 s90, s17, 28
    s_cselect_b32 s17, s17, s90
    s_lshl_b32 s17, s17, 11
    v_mfma_f32_32x32x16_bf16 v[60:75], a[152:155], a[100:103], v[60:75]
    s_add_u32 s17, s17, s32
    buffer_load_dwordx4 a[232:235], v17, s[84:87], s17 offen sc1
    v_mfma_f32_32x32x16_bf16 v[76:91], a[156:159], a[96:99], v[76:91]
    buffer_load_dwordx4 a[236:239], v18, s[84:87], s17 offen sc1
    ds_read_b64_tr_b16 a[16:17], v25 offset:2048
    v_mfma_f32_32x32x16_bf16 v[92:107], a[156:159], a[100:103], v[92:107]
    ds_read_b64_tr_b16 a[18:19], v25 offset:3072
    ds_read_b64_tr_b16 a[20:21], v26 offset:2048
    ds_read_b64_tr_b16 a[22:23], v26 offset:3072
    s_waitcnt vmcnt(12)
    v_mfma_f32_32x32x16_bf16 v[44:59], a[128:131], a[80:83], v[44:59]
    s_add_u32 s17, s92, 21
    s_sub_u32 s90, s17, 28
    s_cselect_b32 s17, s17, s90
    s_lshl_b32 s17, s17, 11
    v_mfma_f32_32x32x16_bf16 v[60:75], a[128:131], a[84:87], v[60:75]
    s_add_u32 s17, s17, s32
    buffer_load_dwordx4 a[248:251], v17, s[84:87], s17 offen sc1
    v_mfma_f32_32x32x16_bf16 v[76:91], a[132:135], a[80:83], v[76:91]
    buffer_load_dwordx4 a[252:255], v18, s[84:87], s17 offen sc1
    ds_read_b64_tr_b16 a[48:49], v25 offset:24576
    v_mfma_f32_32x32x16_bf16 v[92:107], a[132:135], a[84:87], v[92:107]
    ds_read_b64_tr_b16 a[50:51], v25 offset:25600
    ds_read_b64_tr_b16 a[52:53], v26 offset:24576
    ds_read_b64_tr_b16 a[54:55], v26 offset:25600
    buffer_load_dword v8, v5, s[84:87], s30 offen sc1
    s_waitcnt vmcnt(11)
    v_mfma_f32_32x32x16_bf16 v[44:59], a[40:43], a[144:147], v[44:59]
    s_add_u32 s17, s92, 22
    s_sub_u32 s90, s17, 28
    s_cselect_b32 s17, s17, s90
    s_lshl_b32 s17, s17, 11
    v_mfma_f32_32x32x16_bf16 v[60:75], a[40:43], a[148:151], v[60:75]
    s_add_u32 s17, s17, s32
    buffer_load_dwordx4 a[112:115], v17, s[84:87], s17 offen sc1
    v_mfma_f32_32x32x16_bf16 v[76:91], a[44:47], a[144:147], v[76:91]
    buffer_load_dwordx4 a[116:119], v18, s[84:87], s17 offen sc1
    ds_read_b64_tr_b16 a[24:25], v25 offset:26624
    v_mfma_f32_32x32x16_bf16 v[92:107], a[44:47], a[148:151], v[92:107]
    ds_read_b64_tr_b16 a[26:27], v25 offset:27648
    ds_read_b64_tr_b16 a[28:29], v26 offset:26624
    ds_read_b64_tr_b16 a[30:31], v26 offset:27648
    s_waitcnt vmcnt(11)
    v_mfma_f32_32x32x16_bf16 v[44:59], a[136:139], a[192:195], v[44:59]
    s_add_u32 s17, s92, 23
    s_sub_u32 s90, s17, 28
    s_cselect_b32 s17, s17, s90
    s_lshl_b32 s17, s17, 11
    v_mfma_f32_32x32x16_bf16 v[60:75], a[136:139], a[196:199], v[60:75]
    s_add_u32 s17, s17, s32
    buffer_load_dwordx4 a[32:35], v17, s[84:87], s17 offen sc1
    v_mfma_f32_32x32x16_bf16 v[76:91], a[140:143], a[192:195], v[76:91]
    buffer_load_dwordx4 a[36:39], v18, s[84:87], s17 offen sc1
    ds_read_b64_tr_b16 a[64:65], v25 offset:4096
    v_mfma_f32_32x32x16_bf16 v[92:107], a[140:143], a[196:199], v[92:107]
    ds_read_b64_tr_b16 a[66:67], v25 offset:5120
    ds_read_b64_tr_b16 a[68:69], v26 offset:4096
    ds_read_b64_tr_b16 a[70:71], v26 offset:5120
    s_waitcnt vmcnt(11)
    v_mfma_f32_32x32x16_bf16 v[44:59], a[200:203], a[208:211], v[44:59]
    s_add_u32 s17, s92, 24
    s_sub_u32 s90, s17, 28
    s_cselect_b32 s17, s17, s90
    s_lshl_b32 s17, s17, 11
    v_mfma_f32_32x32x16_bf16 v[60:75], a[200:203], a[212:215], v[60:75]
    s_add_u32 s17, s17, s32
    buffer_load_dwordx4 a[120:123], v17, s[84:87], s17 offen sc1
    v_mfma_f32_32x32x16_bf16 v[76:91], a[204:207], a[208:211], v[76:91]
    buffer_load_dwordx4 a[124:127], v18, s[84:87], s17 offen sc1
    ds_read_b64_tr_b16 a[96:97], v25 offset:6144
    v_mfma_f32_32x32x16_bf16 v[92:107], a[204:207], a[212:215], v[92:107]
    ds_read_b64_tr_b16 a[98:99], v25 offset:7168
    ds_read_b64_tr_b16 a[100:101], v26 offset:6144
    ds_read_b64_tr_b16 a[102:103], v26 offset:7168
    s_waitcnt vmcnt(11)
    v_mfma_f32_32x32x16_bf16 v[44:59], a[216:219], a[224:227], v[44:59]
    s_add_u32 s17, s92, 25
    s_sub_u32 s90, s17, 28
    s_cselect_b32 s17, s17, s90
    v_mfma_f32_32x32x16_bf16 v[60:75], a[216:219], a[228:231], v[60:75]
    s_lshl_b32 s17, s17, 11
    s_add_u32 s17, s17, s32
    v_mfma_f32_32x32x16_bf16 v[76:91], a[220:223], a[224:227], v[76:91]
    buffer_load_dwordx4 a[152:155], v17, s[84:87], s17 offen sc1
    v_mfma_f32_32x32x16_bf16 v[92:107], a[220:223], a[228:231], v[92:107]
    buffer_load_dwordx4 a[156:159], v18, s[84:87], s17 offen sc1
    s_waitcnt vmcnt(8)
    v_cmp_ne_u32 vcc, s4, v8
    s_mov_b32 s19, 0x40000
    s_cmp_lg_u64 vcc, 0
    s_cbranch_scc1 L_spin4
L_go4:
    v_mfma_f32_32x32x16_bf16 v[44:59], a[232:235], a[240:243], v[44:59]
    s_add_u32 s17, s92, 26
    s_sub_u32 s90, s17, 28
    s_cselect_b32 s17, s17, s90
    v_mfma_f32_32x32x16_bf16 v[60:75], a[232:235], a[244:247], v[60:75]
    s_lshl_b32 s17, s17, 11
    s_add_u32 s17, s17, s32
    v_mfma_f32_32x32x16_bf16 v[76:91], a[236:239], a[240:243], v[76:91]
    buffer_load_dwordx4 a[80:83], v17, s[84:87], s17 offen sc1
    v_mfma_f32_32x32x16_bf16 v[92:107], a[236:239], a[244:247], v[92:107]
    buffer_load_dwordx4 a[84:87], v18, s[84:87], s17 offen sc1
    v_mfma_f32_32x32x16_bf16 v[44:59], a[248:251], a[160:163], v[44:59]
    s_add_u32 s17, s92, 27
    s_sub_u32 s90, s17, 28
    s_cselect_b32 s17, s17, s90
    v_mfma_f32_32x32x16_bf16 v[60:75], a[248:251], a[164:167], v[60:75]
    s_lshl_b32 s17, s17, 11
    s_add_u32 s17, s17, s32
    v_mfma_f32_32x32x16_bf16 v[76:91], a[252:255], a[160:163], v[76:91]
    buffer_load_dwordx4 a[128:131], v17, s[84:87], s17 offen sc1
    v_mfma_f32_32x32x16_bf16 v[92:107], a[252:255], a[164:167], v[92:107]
    buffer_load_dwordx4 a[132:135], v18, s[84:87], s17 offen sc1
    s_waitcnt vmcnt(10) lgkmcnt(15)
    v_mfma_f32_32x32x16_bf16 v[44:59], a[112:115], a[56:59], v[44:59]
    s_add_u32 s17, s93, 0
    s_and_b32 s17, s17, 7
    s_lshl_b32 s17, s17, 11
    v_mfma_f32_32x32x16_bf16 v[60:75], a[112:115], a[60:63], v[60:75]
    s_add_u32 s17, s17, s34
    v_mfma_f32_32x32x16_bf16 v[76:91], a[116:119], a[56:59], v[76:91]
    buffer_load_dwordx4 a[144:147], v15, s[84:87], s17 offen sc1
    v_mfma_f32_32x32x16_bf16 v[92:107], a[116:119], a[60:63], v[92:107]
    buffer_load_dwordx4 a[148:151], v16, s[84:87], s17 offen sc1
    s_waitcnt vmcnt(10)
    v_mfma_f32_32x32x16_bf16 v[44:59], a[32:35], a[168:171], v[44:59]
    s_add_u32 s17, s93, 1
    s_and_b32 s17, s17, 7
    s_lshl_b32 s17, s17, 11
    v_mfma_f32_32x32x16_bf16 v[60:75], a[32:35], a[172:175], v[60:75]
    s_add_u32 s17, s17, s34
    v_mfma_f32_32x32x16_bf16 v[76:91], a[36:39], a[168:171], v[76:91]
    buffer_load_dwordx4 a[40:43], v15, s[84:87], s17 offen sc1
    v_mfma_f32_32x32x16_bf16 v[92:107], a[36:39], a[172:175], v[92:107]
    buffer_load_dwordx4 a[44:47], v16, s[84:87], s17 offen sc1
    s_waitcnt vmcnt(10)
    v_mfma_f32_32x32x16_bf16 v[44:59], a[120:123], a[72:75], v[44:59]
    s_add_u32 s17, s93, 2
    s_and_b32 s17, s17, 7
    s_lshl_b32 s17, s17, 11
    v_mfma_f32_32x32x16_bf16 v[60:75], a[120:123], a[76:79], v[60:75]
    s_add_u32 s17, s17, s34
    v_mfma_f32_32x32x16_bf16 v[76:91], a[124:127], a[72:75], v[76:91]
    buffer_load_dwordx4 a[192:195], v15, s[84:87], s17 offen sc1
    v_mfma_f32_32x32x16_bf16 v[92:107], a[124:127], a[76:79], v[92:107]
    buffer_load_dwordx4 a[196:199], v16, s[84:87], s17 offen sc1
    s_waitcnt vmcnt(10)
    v_mfma_f32_32x32x16_bf16 v[44:59], a[152:155], a[176:179], v[44:59]
    s_add_u32 s17, s93, 3
    s_and_b32 s17, s17, 7
    s_lshl_b32 s17, s17, 11
    v_mfma_f32_32x32x16_bf16 v[60:75], a[152:155], a[180:183], v[60:75]
    s_add_u32 s17, s17, s34
    v_mfma_f32_32x32x16_bf16 v[76:91], a[156:159], a[176:179], v[76:91]
    buffer_load_dwordx4 a[136:139], v15, s[84:87], s17 offen sc1
    v_mfma_f32_32x32x16_bf16 v[92:107], a[156:159], a[180:183], v[92:107]
    buffer_load_dwordx4 a[140:143], v16, s[84:87], s17 offen sc1
    s_waitcnt vmcnt(10)
    v_mfma_f32_32x32x16_bf16 v[44:59], a[80:83], a[88:91], v[44:59]
    s_add_u32 s17, s93, 4
    s_and_b32 s17, s17, 7
    s_lshl_b32 s17, s17, 11
    v_mfma_f32_32x32x16_bf16 v[60:75], a[80:83], a[92:95], v[60:75]
    s_add_u32 s17, s17, s34
    v_mfma_f32_32x32x16_bf16 v[76:91], a[84:87], a[88:91], v[76:91]
    buffer_load_dwordx4 a[208:211], v15, s[84:87], s17 offen sc1
    v_mfma_f32_32x32x16_bf16 v[92:107], a[84:87], a[92:95], v[92:107]
    buffer_load_dwordx4 a[212:215], v16, s[84:87], s17 offen sc1
    s_waitcnt vmcnt(10)
    v_mfma_f32_32x32x16_bf16 v[44:59], a[128:131], a[0:3], v[44:59]
    s_add_u32 s17, s93, 5
    s_and_b32 s17, s17, 7
    s_lshl_b32 s17, s17, 11
    v_mfma_f32_32x32x16_bf16 v[60:75], a[128:131], a[4:7], v[60:75]
    s_add_u32 s17, s17, s34
    v_mfma_f32_32x32x16_bf16 v[76:91], a[132:135], a[0:3], v[76:91]
    buffer_load_dwordx4 a[200:203], v15, s[84:87], s17 offen sc1
    v_mfma_f32_32x32x16_bf16 v[92:107], a[132:135], a[4:7], v[92:107]
    buffer_load_dwordx4 a[204:207], v16, s[84:87], s17 offen sc1
    s_waitcnt vmcnt(10)
    v_mfma_f32_32x32x16_bf16 v[108:123], a[104:107], a[144:147], 0
    s_add_u32 s17, s93, 6
    s_and_b32 s17, s17, 7
    s_lshl_b32 s17, s17, 11
    v_mfma_f32_32x32x16_bf16 v[124:139], a[104:107], a[148:151], 0
    s_add_u32 s17, s17, s34
    v_mfma_f32_32x32x16_bf16 v[140:155], a[108:111], a[144:147], 0
    buffer_load_dwordx4 a[224:227], v15, s[84:87], s17 offen sc1
    v_mfma_f32_32x32x16_bf16 v[156:171], a[108:111], a[148:151], 0
    buffer_load_dwordx4 a[228:231], v16, s[84:87], s17 offen sc1
    s_waitcnt vmcnt(10)
    v_mfma_f32_32x32x16_bf16 v[108:123], a[8:11], a[40:43], v[108:123]
    s_add_u32 s17, s93, 7
    s_and_b32 s17, s17, 7
    s_lshl_b32 s17, s17, 11
    s_add_u32 s17, s17, s34
    buffer_load_dwordx4 a[216:219], v15, s[84:87], s17 offen sc1
    buffer_load_dwordx4 a[220:223], v16, s[84:87], s17 offen sc1
    v_mfma_f32_32x32x16_bf16 v[124:139], a[8:11], a[44:47], v[124:139]
    v_sub_f32 v38, 1.0, v36
    v_sub_f32 v39, 1.0, v37
    v_cvt_pk_bf16_f32 v2, v38, v39
    v_lshlrev_b32 v38, 16, v2
    v_and_b32 v39, 0xffff0000, v2
    v_lshlrev_b32 v40, 16, v40
    v_add_f32 v44, v44, v40
    v_add_f32 v45, v45, v40
    v_add_f32 v46, v46, v40
    v_add_f32 v47, v47, v40
    v_mfma_f32_32x32x16_bf16 v[140:155], a[12:15], a[40:43], v[140:155]
    v_add_f32 v48, v48, v40
    v_add_f32 v49, v49, v40
    v_add_f32 v50, v50, v40
    v_add_f32 v51, v51, v40
    v_add_f32 v52, v52, v40
    v_add_f32 v53, v53, v40
    v_add_f32 v54, v54, v40
    v_add_f32 v55, v55, v40
    v_add_f32 v56, v56, v40
    v_add_f32 v57, v57, v40
    v_mfma_f32_32x32x16_bf16 v[156:171], a[12:15], a[44:47], v[156:171]
    v_add_f32 v58, v58, v40
    v_add_f32 v59, v59, v40
    v_pk_mul_f32 v[44:45], v[44:45], v[38:39] op_sel:[0,0] op_sel_hi:[1,0]
    v_pk_mul_f32 v[46:47], v[46:47], v[38:39] op_sel:[0,0] op_sel_hi:[1,0]
    v_pk_mul_f32 v[48:49], v[48:49], v[38:39] op_sel:[0,0] op_sel_hi:[1,0]
    v_pk_mul_f32 v[50:51], v[50:51], v[38:39] op_sel:[0,0] op_sel_hi:[1,0]
    v_pk_mul_f32 v[52:53], v[52:53], v[38:39] op_sel:[0,0] op_sel_hi:[1,0]
    v_pk_mul_f32 v[54:55], v[54:55], v[38:39] op_sel:[0,0] op_sel_hi:[1,0]
    v_pk_mul_f32 v[56:57], v[56:57], v[38:39] op_sel:[0,0] op_sel_hi:[1,0]
    v_pk_mul_f32 v[58:59], v[58:59], v[38:39] op_sel:[0,0] op_sel_hi:[1,0]
    s_waitcnt vmcnt(10)
    s_nop 0
    v_mfma_f32_32x32x16_bf16 v[124:139], a[184:187], a[196:199], v[124:139]
    v_pk_mul_f32 v[60:61], v[60:61], v[38:39] op_sel:[0,1] op_sel_hi:[1,1]
    v_pk_mul_f32 v[62:63], v[62:63], v[38:39] op_sel:[0,1] op_sel_hi:[1,1]
    v_pk_mul_f32 v[64:65], v[64:65], v[38:39] op_sel:[0,1] op_sel_hi:[1,1]
    s_nop 1
    v_mfma_f32_32x32x16_bf16 v[140:155], a[188:191], a[192:195], v[140:155]
    v_pk_mul_f32 v[66:67], v[66:67], v[38:39] op_sel:[0,1] op_sel_hi:[1,1]
    v_pk_mul_f32 v[68:69], v[68:69], v[38:39] op_sel:[0,1] op_sel_hi:[1,1]
    s_nop 1
    v_mfma_f32_32x32x16_bf16 v[156:171], a[188:191], a[196:199], v[156:171]
    v_pk_mul_f32 v[70:71], v[70:71], v[38:39] op_sel:[0,1] op_sel_hi:[1,1]
    v_pk_mul_f32 v[72:73], v[72:73], v[38:39] op_sel:[0,1] op_sel_hi:[1,1]
    v_pk_mul_f32 v[74:75], v[74:75], v[38:39] op_sel:[0,1] op_sel_hi:[1,1]
    s_waitcnt vmcnt(8)
    s_nop 0
    v_mfma_f32_32x32x16_bf16 v[124:139], a[16:19], a[140:143], v[124:139]
    v_pk_mul_f32 v[76:77], v[76:77], v[38:39] op_sel:[0,0] op_sel_hi:[1,0]
    v_pk_mul_f32 v[78:79], v[78:79], v[38:39] op_sel:[0,0] op_sel_hi:[1,0]
    v_pk_mul_f32 v[80:81], v[80:81], v[38:39] op_sel:[0,0] op_sel_hi:[1,0]
    s_nop 1
    v_mfma_f32_32x32x16_bf16 v[140:155], a[20:23], a[136:139], v[140:155]
    v_pk_mul_f32 v[82:83], v[82:83], v[38:39] op_sel:[0,0] op_sel_hi:[1,0]
    v_pk_mul_f32 v[84:85], v[84:85], v[38:39] op_sel:[0,0] op_sel_hi:[1,0]
    s_nop 1
    v_mfma_f32_32x32x16_bf16 v[156:171], a[20:23], a[140:143], v[156:171]
    v_pk_mul_f32 v[86:87], v[86:87], v[38:39] op_sel:[0,0] op_sel_hi:[1,0]
    v_pk_mul_f32 v[88:89], v[88:89], v[38:39] op_sel:[0,0] op_sel_hi:[1,0]
    v_pk_mul_f32 v[90:91], v[90:91], v[38:39] op_sel:[0,0] op_sel_hi:[1,0]
    s_waitcnt vmcnt(6) lgkmcnt(12)
    s_nop 0
    v_mfma_f32_32x32x16_bf16 v[124:139], a[48:51], a[212:215], v[124:139]
    v_pk_mul_f32 v[92:93], v[92:93], v[38:39] op_sel:[0,1] op_sel_hi:[1,1]
    v_pk_mul_f32 v[94:95], v[94:95], v[38:39] op_sel:[0,1] op_sel_hi:[1,1]
    v_pk_mul_f32 v[96:97], v[96:97], v[38:39] op_sel:[0,1] op_sel_hi:[1,1]
    s_nop 1
    v_mfma_f32_32x32x16_bf16 v[140:155], a[52:55], a[208:211], v[140:155]
    v_pk_mul_f32 v[98:99], v[98:99], v[38:39] op_sel:[0,1] op_sel_hi:[1,1]
    v_pk_mul_f32 v[100:101], v[100:101], v[38:39] op_sel:[0,1] op_sel_hi:[1,1]
    s_nop 1
    v_mfma_f32_32x32x16_bf16 v[156:171], a[52:55], a[212:215], v[156:171]
    v_pk_mul_f32 v[102:103], v[102:103], v[38:39] op_sel:[0,1] op_sel_hi:[1,1]
    v_pk_mul_f32 v[104:105], v[104:105], v[38:39] op_sel:[0,1] op_sel_hi:[1,1]
    v_pk_mul_f32 v[106:107], v[106:107], v[38:39] op_sel:[0,1] op_sel_hi:[1,1]
    s_waitcnt vmcnt(4) lgkmcnt(8)
    s_nop 0
    v_mfma_f32_32x32x16_bf16 v[124:139], a[24:27], a[204:207], v[124:139]
    v_mfma_f32_32x32x16_bf16 v[140:155], a[28:31], a[200:203], v[140:155]
    v_mfma_f32_32x32x16_bf16 v[156:171], a[28:31], a[204:207], v[156:171]
    s_waitcnt vmcnt(2) lgkmcnt(4)
    v_mfma_f32_32x32x16_bf16 v[124:139], a[64:67], a[228:231], v[124:139]
    v_mfma_f32_32x32x16_bf16 v[140:155], a[68:71], a[224:227], v[140:155]
    v_mfma_f32_32x32x16_bf16 v[156:171], a[68:71], a[228:231], v[156:171]
    s_waitcnt vmcnt(0) lgkmcnt(0)
    v_mfma_f32_32x32x16_bf16 v[124:139], a[96:99], a[220:223], v[124:139]
    v_mfma_f32_32x32x16_bf16 v[140:155], a[100:103], a[216:219], v[140:155]
    v_mfma_f32_32x32x16_bf16 v[156:171], a[100:103], a[220:223], v[156:171]
    v_mfma_f32_32x32x16_bf16 v[108:123], a[184:187], a[192:195], v[108:123]
    v_mfma_f32_32x32x16_bf16 v[108:123], a[16:19], a[136:139], v[108:123]
    s_nop 7
    v_pk_fma_f32 v[60:61], v[124:125], v[36:37], v[60:61] op_sel:[0,1,0] op_sel_hi:[1,1,1]
    v_pk_fma_f32 v[62:63], v[126:127], v[36:37], v[62:63] op_sel:[0,1,0] op_sel_hi:[1,1,1]
    v_pk_fma_f32 v[64:65], v[128:129], v[36:37], v[64:65] op_sel:[0,1,0] op_sel_hi:[1,1,1]
    v_pk_fma_f32 v[66:67], v[130:131], v[36:37], v[66:67] op_sel:[0,1,0] op_sel_hi:[1,1,1]
    v_pk_fma_f32 v[68:69], v[132:133], v[36:37], v[68:69] op_sel:[0,1,0] op_sel_hi:[1,1,1]
    v_pk_fma_f32 v[70:71], v[134:135], v[36:37], v[70:71] op_sel:[0,1,0] op_sel_hi:[1,1,1]
    v_pk_fma_f32 v[72:73], v[136:137], v[36:37], v[72:73] op_sel:[0,1,0] op_sel_hi:[1,1,1]
    v_pk_fma_f32 v[74:75], v[138:139], v[36:37], v[74:75] op_sel:[0,1,0] op_sel_hi:[1,1,1]
    ds_write_b128 v27, v[60:63] offset:28672
    ds_write_b128 v27, v[64:67] offset:29696
    v_mfma_f32_32x32x16_bf16 v[108:123], a[48:51], a[208:211], v[108:123]
    ds_write_b128 v27, v[68:71] offset:30720
    ds_write_b128 v27, v[72:75] offset:31744
    v_mfma_f32_32x32x16_bf16 v[108:123], a[24:27], a[200:203], v[108:123]
    v_pk_fma_f32 v[76:77], v[140:141], v[36:37], v[76:77] op_sel:[0,0,0] op_sel_hi:[1,0,1]
    v_pk_fma_f32 v[78:79], v[142:143], v[36:37], v[78:79] op_sel:[0,0,0] op_sel_hi:[1,0,1]
    v_pk_fma_f32 v[80:81], v[144:145], v[36:37], v[80:81] op_sel:[0,0,0] op_sel_hi:[1,0,1]
    v_pk_fma_f32 v[82:83], v[146:147], v[36:37], v[82:83] op_sel:[0,0,0] op_sel_hi:[1,0,1]
    v_pk_fma_f32 v[84:85], v[148:149], v[36:37], v[84:85] op_sel:[0,0,0] op_sel_hi:[1,0,1]
    v_pk_fma_f32 v[86:87], v[150:151], v[36:37], v[86:87] op_sel:[0,0,0] op_sel_hi:[1,0,1]
    v_pk_fma_f32 v[88:89], v[152:153], v[36:37], v[88:89] op_sel:[0,0,0] op_sel_hi:[1,0,1]
    v_pk_fma_f32 v[90:91], v[154:155], v[36:37], v[90:91] op_sel:[0,0,0] op_sel_hi:[1,0,1]
    ds_write_b128 v27, v[76:79] offset:32768
    ds_write_b128 v27, v[80:83] offset:33792
    v_mfma_f32_32x32x16_bf16 v[108:123], a[64:67], a[224:227], v[108:123]
    ds_write_b128 v27, v[84:87] offset:34816
    ds_write_b128 v27, v[88:91] offset:35840
    v_mfma_f32_32x32x16_bf16 v[108:123], a[96:99], a[216:219], v[108:123]
    v_pk_fma_f32 v[92:93], v[156:157], v[36:37], v[92:93] op_sel:[0,1,0] op_sel_hi:[1,1,1]
    v_pk_fma_f32 v[94:95], v[158:159], v[36:37], v[94:95] op_sel:[0,1,0] op_sel_hi:[1,1,1]
    v_pk_fma_f32 v[96:97], v[160:161], v[36:37], v[96:97] op_sel:[0,1,0] op_sel_hi:[1,1,1]
    v_pk_fma_f32 v[98:99], v[162:163], v[36:37], v[98:99] op_sel:[0,1,0] op_sel_hi:[1,1,1]
    v_pk_fma_f32 v[100:101], v[164:165], v[36:37], v[100:101] op_sel:[0,1,0] op_sel_hi:[1,1,1]
    v_pk_fma_f32 v[102:103], v[166:167], v[36:37], v[102:103] op_sel:[0,1,0] op_sel_hi:[1,1,1]
    v_pk_fma_f32 v[104:105], v[168:169], v[36:37], v[104:105] op_sel:[0,1,0] op_sel_hi:[1,1,1]
    v_pk_fma_f32 v[106:107], v[170:171], v[36:37], v[106:107] op_sel:[0,1,0] op_sel_hi:[1,1,1]
    ds_write_b128 v27, v[92:95] offset:36864
    ds_write_b128 v27, v[96:99] offset:37888
    ds_write_b128 v27, v[100:103] offset:38912
    ds_write_b128 v27, v[104:107] offset:39936
    s_waitcnt lgkmcnt(0)
    s_barrier
    ds_read_b128 v[60:63], v172 offset:28672
    ds_read_b128 v[64:67], v172 offset:29696
    ds_read_b128 v[68:71], v172 offset:30720
    ds_read_b128 v[72:75], v172 offset:31744
    ds_read_b128 v[76:79], v173 offset:32768
    ds_read_b128 v[80:83], v173 offset:33792
    ds_read_b128 v[84:87], v173 offset:34816
    ds_read_b128 v[88:91], v173 offset:35840
    ds_read_b128 v[92:95], v174 offset:36864
    ds_read_b128 v[96:99], v174 offset:37888
    ds_read_b128 v[100:103], v174 offset:38912
    ds_read_b128 v[104:107], v174 offset:39936
    v_pk_fma_f32 v[44:45], v[108:109], v[36:37], v[44:45] op_sel:[0,0,0] op_sel_hi:[1,0,1]
    v_pk_fma_f32 v[46:47], v[110:111], v[36:37], v[46:47] op_sel:[0,0,0] op_sel_hi:[1,0,1]
    v_pk_fma_f32 v[48:49], v[112:113], v[36:37], v[48:49] op_sel:[0,0,0] op_sel_hi:[1,0,1]
    v_pk_fma_f32 v[50:51], v[114:115], v[36:37], v[50:51] op_sel:[0,0,0] op_sel_hi:[1,0,1]
    v_pk_fma_f32 v[52:53], v[116:117], v[36:37], v[52:53] op_sel:[0,0,0] op_sel_hi:[1,0,1]
    v_pk_fma_f32 v[54:55], v[118:119], v[36:37], v[54:55] op_sel:[0,0,0] op_sel_hi:[1,0,1]
    v_pk_fma_f32 v[56:57], v[120:121], v[36:37], v[56:57] op_sel:[0,0,0] op_sel_hi:[1,0,1]
    v_pk_fma_f32 v[58:59], v[122:123], v[36:37], v[58:59] op_sel:[0,0,0] op_sel_hi:[1,0,1]
    s_waitcnt lgkmcnt(8)
    v_pk_add_f32 v[44:45], v[44:45], v[60:61]
    v_pk_add_f32 v[46:47], v[46:47], v[62:63]
    v_pk_add_f32 v[48:49], v[48:49], v[64:65]
    v_pk_add_f32 v[50:51], v[50:51], v[66:67]
    v_pk_add_f32 v[52:53], v[52:53], v[68:69]
    v_pk_add_f32 v[54:55], v[54:55], v[70:71]
    v_pk_add_f32 v[56:57], v[56:57], v[72:73]
    v_pk_add_f32 v[58:59], v[58:59], v[74:75]
    s_waitcnt lgkmcnt(4)
    v_pk_add_f32 v[44:45], v[44:45], v[76:77]
    v_pk_add_f32 v[46:47], v[46:47], v[78:79]
    v_pk_add_f32 v[48:49], v[48:49], v[80:81]
    v_pk_add_f32 v[50:51], v[50:51], v[82:83]
    v_pk_add_f32 v[52:53], v[52:53], v[84:85]
    v_pk_add_f32 v[54:55], v[54:55], v[86:87]
    v_pk_add_f32 v[56:57], v[56:57], v[88:89]
    v_pk_add_f32 v[58:59], v[58:59], v[90:91]
    s_waitcnt lgkmcnt(0)
    v_pk_add_f32 v[44:45], v[44:45], v[92:93]
    v_pk_add_f32 v[46:47], v[46:47], v[94:95]
    v_pk_add_f32 v[48:49], v[48:49], v[96:97]
    v_pk_add_f32 v[50:51], v[50:51], v[98:99]
    v_pk_add_f32 v[52:53], v[52:53], v[100:101]
    v_pk_add_f32 v[54:55], v[54:55], v[102:103]
    v_pk_add_f32 v[56:57], v[56:57], v[104:105]
    v_pk_add_f32 v[58:59], v[58:59], v[106:107]
    v_cvt_pk_bf16_f32 v108, v44, v45
    v_cvt_pk_bf16_f32 v109, v46, v47
    v_cvt_pk_bf16_f32 v110, v48, v49
    v_cvt_pk_bf16_f32 v111, v50, v51
    v_cvt_pk_bf16_f32 v112, v52, v53
    v_cvt_pk_bf16_f32 v113, v54, v55
    v_cvt_pk_bf16_f32 v114, v56, v57
    v_cvt_pk_bf16_f32 v115, v58, v59
    v_permlane32_swap_b32 v108, v110
    v_permlane32_swap_b32 v109, v111
    buffer_store_dwordx4 v[108:111], v175, s[80:83], s14 offen offset:0
    v_permlane32_swap_b32 v112, v114
    v_permlane32_swap_b32 v113, v115
    buffer_store_dwordx4 v[112:115], v175, s[80:83], s14 offen offset:32
    s_or_b32 s5, s2, s3
    s_cmp_lg_u32 s5, 0
    s_cbranch_scc1 L_noe
    s_mov_b32 s5, 0xc38000
    v_mov_b32 v2, s4
    s_mov_b32 exec_hi, 0
    buffer_store_dword v2, v42, s[84:87], s5 offen sc1
    s_mov_b64 exec, -1
L_noe:
L_end:
    s_endpgm
L_attn:
    v_lshrrev_b32 v2, 2, v1
    v_and_b32 v3, 3, v1
    v_lshlrev_b32 v3, 7, v3
    v_lshl_add_u32 v43, v2, 12, v3
    s_bfe_u32 s5, s11, 0x20002
    s_mul_i32 s5, s5, 28
    s_add_u32 s5, s5, s3
    s_lshl_b32 s42, s5, 16
    s_lshl_b32 s5, s96, 9
    s_add_u32 s42, s42, s5
    s_and_b32 s43, s11, 15
    s_lshl_b32 s43, s43, 15
    s_add_u32 s90, s42, 0
    buffer_load_dword v45, v43, s[68:71], s90 offen
    s_add_u32 s90, s42, 262144
    buffer_load_dword v45, v43, s[68:71], s90 offen
    s_add_u32 s90, s42, 524288
    buffer_load_dword v45, v43, s[68:71], s90 offen
    s_add_u32 s90, s42, 786432
    buffer_load_dword v45, v43, s[68:71], s90 offen
    s_add_u32 s90, s42, 1048576
    buffer_load_dword v45, v43, s[68:71], s90 offen
    s_lshr_b32 s5, s27, 3
    s_lshl_b32 s5, s5, 1
    s_bfe_u32 s6, s27, 0x10001
    s_add_u32 s5, s5, s6
    s_lshl_b32 s5, s5, 2
    s_add_u32 s5, s5, s3
    s_lshl_b32 s5, s5, 10
    s_add_u32 s23, s5, 0xc18000
    s_lshr_b32 s5, s27, 1
    s_lshl_b32 s5, s5, 2
    s_add_u32 s5, s5, s3
    s_lshl_b32 s5, s5, 10
    s_add_u32 s24, s5, 0xc20000
    v_and_b32 v9, 896, v7
    v_and_b32 v2, 31, v1
    v_min_u32 v2, 16, v2
    v_and_b32 v3, 32, v1
    v_add_lshl_u32 v11, v2, v3, 4
    s_lshl_b32 s25, s27, 17
    s_lshl_b32 s6, s3, 15
    s_add_u32 s25, s25, s6
    s_add_u32 s25, s25, 0x800000
    buffer_load_dword v8, v9, s[84:87], s24 offen sc1
    s_waitcnt vmcnt(0)
    v_cmp_ne_u32 vcc, s4, v8
    s_mov_b32 s19, 0x40000
    s_cmp_lg_u64 vcc, 0
    s_cbranch_scc1 L_spin5
L_go5:
    buffer_load_dword v8, v9, s[84:87], s23 offen sc1
    buffer_load_dwordx4 v[104:107], v11, s[84:87], s25 offen offset:0 sc1
    buffer_load_dwordx4 v[108:111], v11, s[84:87], s25 offen offset:1024 sc1
    buffer_load_dwordx4 v[112:115], v11, s[84:87], s25 offen offset:2048 sc1
    buffer_load_dwordx4 v[116:119], v11, s[84:87], s25 offen offset:3072 sc1
    s_add_u32 s25, s25, 4096
    buffer_load_dwordx4 v[120:123], v11, s[84:87], s25 offen offset:0 sc1
    buffer_load_dwordx4 v[124:127], v11, s[84:87], s25 offen offset:1024 sc1
    buffer_load_dwordx4 v[128:131], v11, s[84:87], s25 offen offset:2048 sc1
    buffer_load_dwordx4 v[132:135], v11, s[84:87], s25 offen offset:3072 sc1
    s_add_u32 s25, s25, 4096
    buffer_load_dwordx4 v[136:139], v11, s[84:87], s25 offen offset:0 sc1
    buffer_load_dwordx4 v[140:143], v11, s[84:87], s25 offen offset:1024 sc1
    buffer_load_dwordx4 v[144:147], v11, s[84:87], s25 offen offset:2048 sc1
    buffer_load_dwordx4 v[148:151], v11, s[84:87], s25 offen offset:3072 sc1
    s_add_u32 s25, s25, 4096
    buffer_load_dwordx4 v[152:155], v11, s[84:87], s25 offen offset:0 sc1
    buffer_load_dwordx4 v[156:159], v11, s[84:87], s25 offen offset:1024 sc1
    buffer_load_dwordx4 v[160:163], v11, s[84:87], s25 offen offset:2048 sc1
    buffer_load_dwordx4 v[164:167], v11, s[84:87], s25 offen offset:3072 sc1
    s_add_u32 s25, s25, 4096
    buffer_load_dwordx4 v[168:171], v11, s[84:87], s25 offen offset:0 sc1
    buffer_load_dwordx4 v[172:175], v11, s[84:87], s25 offen offset:1024 sc1
    buffer_load_dwordx4 v[176:179], v11, s[84:87], s25 offen offset:2048 sc1
    buffer_load_dwordx4 v[180:183], v11, s[84:87], s25 offen offset:3072 sc1
    s_add_u32 s25, s25, 4096
    buffer_load_dwordx4 v[184:187], v11, s[84:87], s25 offen offset:0 sc1
    buffer_load_dwordx4 v[188:191], v11, s[84:87], s25 offen offset:1024 sc1
    buffer_load_dwordx4 v[192:195], v11, s[84:87], s25 offen offset:2048 sc1
    buffer_load_dwordx4 v[196:199], v11, s[84:87], s25 offen offset:3072 sc1
    s_add_u32 s25, s25, 4096
    buffer_load_dwordx4 v[200:203], v11, s[84:87], s25 offen offset:0 sc1
    buffer_load_dwordx4 v[204:207], v11, s[84:87], s25 offen offset:1024 sc1
    buffer_load_dwordx4 v[208:211], v11, s[84:87], s25 offen offset:2048 sc1
    buffer_load_dwordx4 v[212:215], v11, s[84:87], s25 offen offset:3072 sc1
    s_add_u32 s25, s25, 4096
    buffer_load_dwordx4 v[216:219], v11, s[84:87], s25 offen offset:0 sc1
    buffer_load_dwordx4 v[220:223], v11, s[84:87], s25 offen offset:1024 sc1
    buffer_load_dwordx4 v[224:227], v11, s[84:87], s25 offen offset:2048 sc1
    buffer_load_dwordx4 v[228:231], v11, s[84:87], s25 offen offset:3072 sc1
    s_add_u32 s25, s25, 4096
    s_waitcnt vmcnt(32)
    v_cmp_ne_u32 vcc, s4, v8
    s_mov_b32 s19, 0x40000
    s_cmp_lg_u64 vcc, 0
    s_cbranch_scc1 L_spin6
L_go6:
    s_waitcnt vmcnt(24)
    v_pk_add_f32 v[104:105], v[104:105], v[120:121]
    v_pk_add_f32 v[106:107], v[106:107], v[122:123]
    v_pk_add_f32 v[108:109], v[108:109], v[124:125]
    v_pk_add_f32 v[110:111], v[110:111], v[126:127]
    v_pk_add_f32 v[112:113], v[112:113], v[128:129]
    v_pk_add_f32 v[114:115], v[114:115], v[130:131]
    v_pk_add_f32 v[116:117], v[116:117], v[132:133]
    v_pk_add_f32 v[118:119], v[118:119], v[134:135]
    s_waitcnt vmcnt(20)
    v_pk_add_f32 v[104:105], v[104:105], v[136:137]
    v_pk_add_f32 v[106:107], v[106:107], v[138:139]
    v_pk_add_f32 v[108:109], v[108:109], v[140:141]
    v_pk_add_f32 v[110:111], v[110:111], v[142:143]
    v_pk_add_f32 v[112:113], v[112:113], v[144:145]
    v_pk_add_f32 v[114:115], v[114:115], v[146:147]
    v_pk_add_f32 v[116:117], v[116:117], v[148:149]
    v_pk_add_f32 v[118:119], v[118:119], v[150:151]
    s_waitcnt vmcnt(16)
    v_pk_add_f32 v[104:105], v[104:105], v[152:153]
    v_pk_add_f32 v[106:107], v[106:107], v[154:155]
    v_pk_add_f32 v[108:109], v[108:109], v[156:157]
    v_pk_add_f32 v[110:111], v[110:111], v[158:159]
    v_pk_add_f32 v[112:113], v[112:113], v[160:161]
    v_pk_add_f32 v[114:115], v[114:115], v[162:163]
    v_pk_add_f32 v[116:117], v[116:117], v[164:165]
    v_pk_add_f32 v[118:119], v[118:119], v[166:167]
    s_waitcnt vmcnt(12)
    v_pk_add_f32 v[104:105], v[104:105], v[168:169]
    v_pk_add_f32 v[106:107], v[106:107], v[170:171]
    v_pk_add_f32 v[108:109], v[108:109], v[172:173]
    v_pk_add_f32 v[110:111], v[110:111], v[174:175]
    v_pk_add_f32 v[112:113], v[112:113], v[176:177]
    v_pk_add_f32 v[114:115], v[114:115], v[178:179]
    v_pk_add_f32 v[116:117], v[116:117], v[180:181]
    v_pk_add_f32 v[118:119], v[118:119], v[182:183]
    s_waitcnt vmcnt(8)
    v_pk_add_f32 v[104:105], v[104:105], v[184:185]
    v_pk_add_f32 v[106:107], v[106:107], v[186:187]
    v_pk_add_f32 v[108:109], v[108:109], v[188:189]
    v_pk_add_f32 v[110:111], v[110:111], v[190:191]
    v_pk_add_f32 v[112:113], v[112:113], v[192:193]
    v_pk_add_f32 v[114:115], v[114:115], v[194:195]
    v_pk_add_f32 v[116:117], v[116:117], v[196:197]
    v_pk_add_f32 v[118:119], v[118:119], v[198:199]
    s_waitcnt vmcnt(4)
    v_pk_add_f32 v[104:105], v[104:105], v[200:201]
    v_pk_add_f32 v[106:107], v[106:107], v[202:203]
    v_pk_add_f32 v[108:109], v[108:109], v[204:205]
    v_pk_add_f32 v[110:111], v[110:111], v[206:207]
    v_pk_add_f32 v[112:113], v[112:113], v[208:209]
    v_pk_add_f32 v[114:115], v[114:115], v[210:211]
    v_pk_add_f32 v[116:117], v[116:117], v[212:213]
    v_pk_add_f32 v[118:119], v[118:119], v[214:215]
    s_waitcnt vmcnt(0)
    v_pk_add_f32 v[104:105], v[104:105], v[216:217]
    v_pk_add_f32 v[106:107], v[106:107], v[218:219]
    v_pk_add_f32 v[108:109], v[108:109], v[220:221]
    v_pk_add_f32 v[110:111], v[110:111], v[222:223]
    v_pk_add_f32 v[112:113], v[112:113], v[224:225]
    v_pk_add_f32 v[114:115], v[114:115], v[226:227]
    v_pk_add_f32 v[116:117], v[116:117], v[228:229]
    v_pk_add_f32 v[118:119], v[118:119], v[230:231]
    ds_write_b128 v27, v[104:107] offset:28672
    ds_write_b128 v27, v[108:111] offset:29696
    ds_write_b128 v27, v[112:115] offset:30720
    ds_write_b128 v27, v[116:119] offset:31744
    s_xor_b32 s5, s3, 1
    s_mul_i32 s5, s5, 40960
    v_add_u32 v2, s5, v6
    s_xor_b32 s5, s3, 2
    s_mul_i32 s5, s5, 40960
    v_add_u32 v3, s5, v6
    s_xor_b32 s5, s3, 3
    s_mul_i32 s5, s5, 40960
    v_add_u32 v4, s5, v6
    s_waitcnt lgkmcnt(0)
    s_barrier
    ds_read_b128 v[72:75], v2 offset:28672
    ds_read_b128 v[76:79], v2 offset:29696
    ds_read_b128 v[80:83], v2 offset:30720
    ds_read_b128 v[84:87], v2 offset:31744
    ds_read_b128 v[88:91], v3 offset:28672
    ds_read_b128 v[92:95], v3 offset:29696
    ds_read_b128 v[96:99], v3 offset:30720
    ds_read_b128 v[100:103], v3 offset:31744
    s_waitcnt lgkmcnt(4)
    v_pk_add_f32 v[104:105], v[104:105], v[72:73]
    v_pk_add_f32 v[106:107], v[106:107], v[74:75]
    v_pk_add_f32 v[108:109], v[108:109], v[76:77]
    v_pk_add_f32 v[110:111], v[110:111], v[78:79]
    v_pk_add_f32 v[112:113], v[112:113], v[80:81]
    v_pk_add_f32 v[114:115], v[114:115], v[82:83]
    v_pk_add_f32 v[116:117], v[116:117], v[84:85]
    v_pk_add_f32 v[118:119], v[118:119], v[86:87]
    ds_read_b128 v[72:75], v4 offset:28672
    ds_read_b128 v[76:79], v4 offset:29696
    ds_read_b128 v[80:83], v4 offset:30720
    ds_read_b128 v[84:87], v4 offset:31744
    s_waitcnt lgkmcnt(0)
    v_pk_add_f32 v[88:89], v[88:89], v[72:73]
    v_pk_add_f32 v[90:91], v[90:91], v[74:75]
    v_pk_add_f32 v[92:93], v[92:93], v[76:77]
    v_pk_add_f32 v[94:95], v[94:95], v[78:79]
    v_pk_add_f32 v[96:97], v[96:97], v[80:81]
    v_pk_add_f32 v[98:99], v[98:99], v[82:83]
    v_pk_add_f32 v[100:101], v[100:101], v[84:85]
    v_pk_add_f32 v[102:103], v[102:103], v[86:87]
    v_pk_add_f32 v[104:105], v[104:105], v[88:89]
    v_pk_add_f32 v[106:107], v[106:107], v[90:91]
    v_pk_add_f32 v[108:109], v[108:109], v[92:93]
    v_pk_add_f32 v[110:111], v[110:111], v[94:95]
    v_pk_add_f32 v[112:113], v[112:113], v[96:97]
    v_pk_add_f32 v[114:115], v[114:115], v[98:99]
    v_pk_add_f32 v[116:117], v[116:117], v[100:101]
    v_pk_add_f32 v[118:119], v[118:119], v[102:103]
    v_cvt_pk_bf16_f32 v48, v104, v105
    v_cvt_pk_bf16_f32 v49, v106, v107
    v_cvt_pk_bf16_f32 v50, v108, v109
    v_cvt_pk_bf16_f32 v51, v110, v111
    v_cvt_pk_bf16_f32 v52, v112, v113
    v_cvt_pk_bf16_f32 v53, v114, v115
    v_cvt_pk_bf16_f32 v54, v116, v117
    v_cvt_pk_bf16_f32 v55, v118, v119
    s_mov_b32 exec_lo, 0x00220000
    s_mov_b32 exec_hi, 0x00220000
    v_mov_b32 v48, 0x3f803f80
    v_mov_b32 v49, 0x3f803f80
    v_mov_b32 v50, 0x3f803f80
    v_mov_b32 v51, 0x3f803f80
    v_mov_b32 v52, 0x3f803f80
    v_mov_b32 v53, 0x3f803f80
    v_mov_b32 v54, 0x3f803f80
    v_mov_b32 v55, 0x3f803f80
    s_mov_b64 exec, -1
    s_lshl_b32 s5, s27, 11
    s_lshl_b32 s6, s3, 16
    s_add_u32 s5, s5, s6
    s_add_u32 s5, s5, 0x200000
    buffer_store_dwordx4 v[48:51], v6, s[84:87], s5 offen offset:0 sc1
    buffer_store_dwordx4 v[52:55], v6, s[84:87], s5 offen offset:1024 sc1
    s_lshl_b32 s5, s3, 5
    s_add_u32 s5, s5, s27
    s_lshl_b32 s5, s5, 7
    s_add_u32 s8, s5, 0xc34000
    s_waitcnt vmcnt(0)
    v_mov_b32 v2, s4
    s_mov_b32 exec_hi, 0
    buffer_store_dword v2, v42, s[84:87], s8 offen sc1
    s_mov_b64 exec, -1
    s_add_u32 s90, s42, 1310720
    buffer_load_dword v45, v43, s[68:71], s90 offen
    s_add_u32 s90, s42, 1572864
    buffer_load_dword v45, v43, s[68:71], s90 offen
    s_add_u32 s5, s96, 0
    s_and_b32 s5, s5, 3
    s_lshl_b32 s5, s5, 13
    s_add_u32 s5, s5, s43
    s_add_u32 s90, s5, 0
    buffer_load_dword v45, v7, s[76:79], s90 offen
    s_add_u32 m0, s20, 12288
    s_add_u32 s16, s92, 0
    s_sub_u32 s90, s16, 28
    s_cselect_b32 s16, s16, s90
    s_lshl_b32 s16, s16, 16
    s_add_u32 s16, s16, s33
    buffer_load_dwordx4 v19, s[68:71], s16 offen lds
    buffer_load_dwordx4 v20, s[68:71], s16 offen offset:1024 lds
    s_add_u32 m0, s20, 14336
    s_add_u32 s16, s92, 1
    s_sub_u32 s90, s16, 28
    s_cselect_b32 s16, s16, s90
    s_lshl_b32 s16, s16, 16
    s_add_u32 s16, s16, s33
    buffer_load_dwordx4 v19, s[68:71], s16 offen lds
    buffer_load_dwordx4 v20, s[68:71], s16 offen offset:1024 lds
    s_add_u32 m0, s20, 0
    s_add_u32 s16, s92, 2
    s_sub_u32 s90, s16, 28
    s_cselect_b32 s16, s16, s90
    s_lshl_b32 s16, s16, 16
    s_add_u32 s16, s16, s33
    buffer_load_dwordx4 v19, s[68:71], s16 offen lds
    buffer_load_dwordx4 v20, s[68:71], s16 offen offset:1024 lds
    s_add_u32 m0, s20, 2048
    s_add_u32 s16, s92, 3
    s_sub_u32 s90, s16, 28
    s_cselect_b32 s16, s16, s90
    s_lshl_b32 s16, s16, 16
    s_add_u32 s16, s16, s33
    buffer_load_dwordx4 v19, s[68:71], s16 offen lds
    buffer_load_dwordx4 v20, s[68:71], s16 offen offset:1024 lds
    s_add_u32 m0, s20, 24576
    s_add_u32 s16, s92, 4
    s_sub_u32 s90, s16, 28
    s_cselect_b32 s16, s16, s90
    s_lshl_b32 s16, s16, 16
    s_add_u32 s16, s16, s33
    buffer_load_dwordx4 v19, s[68:71], s16 offen lds
    buffer_load_dwordx4 v20, s[68:71], s16 offen offset:1024 lds
    s_waitcnt vmcnt(8)
    ds_read_b64_tr_b16 a[160:161], v23 offset:12288
    ds_read_b64_tr_b16 a[162:163], v23 offset:13312
    ds_read_b64_tr_b16 a[164:165], v24 offset:12288
    ds_read_b64_tr_b16 a[166:167], v24 offset:13312
    s_add_u32 m0, s20, 26624
    s_add_u32 s16, s92, 5
    s_sub_u32 s90, s16, 28
    s_cselect_b32 s16, s16, s90
    s_lshl_b32 s16, s16, 16
    s_add_u32 s16, s16, s33
    buffer_load_dwordx4 v19, s[68:71], s16 offen lds
    buffer_load_dwordx4 v20, s[68:71], s16 offen offset:1024 lds
    s_waitcnt vmcnt(8)
    ds_read_b64_tr_b16 a[56:57], v23 offset:14336
    ds_read_b64_tr_b16 a[58:59], v23 offset:15360
    ds_read_b64_tr_b16 a[60:61], v24 offset:14336
    ds_read_b64_tr_b16 a[62:63], v24 offset:15360
    s_add_u32 m0, s20, 4096
    s_add_u32 s16, s92, 6
    s_sub_u32 s90, s16, 28
    s_cselect_b32 s16, s16, s90
    s_lshl_b32 s16, s16, 16
    s_add_u32 s16, s16, s33
    buffer_load_dwordx4 v19, s[68:71], s16 offen lds
    buffer_load_dwordx4 v20, s[68:71], s16 offen offset:1024 lds
    s_waitcnt vmcnt(8)
    ds_read_b64_tr_b16 a[168:169], v23 offset:0
    ds_read_b64_tr_b16 a[170:171], v23 offset:1024
    ds_read_b64_tr_b16 a[172:173], v24 offset:0
    ds_read_b64_tr_b16 a[174:175], v24 offset:1024
    s_add_u32 m0, s20, 6144
    s_add_u32 s16, s92, 7
    s_sub_u32 s90, s16, 28
    s_cselect_b32 s16, s16, s90
    s_lshl_b32 s16, s16, 16
    s_add_u32 s16, s16, s33
    buffer_load_dwordx4 v19, s[68:71], s16 offen lds
    buffer_load_dwordx4 v20, s[68:71], s16 offen offset:1024 lds
    s_waitcnt vmcnt(8)
    ds_read_b64_tr_b16 a[72:73], v23 offset:2048
    ds_read_b64_tr_b16 a[74:75], v23 offset:3072
    ds_read_b64_tr_b16 a[76:77], v24 offset:2048
    ds_read_b64_tr_b16 a[78:79], v24 offset:3072
    s_add_u32 m0, s20, 8192
    s_add_u32 s16, s92, 8
    s_sub_u32 s90, s16, 28
    s_cselect_b32 s16, s16, s90
    s_lshl_b32 s16, s16, 16
    s_add_u32 s16, s16, s33
    buffer_load_dwordx4 v19, s[68:71], s16 offen lds
    buffer_load_dwordx4 v20, s[68:71], s16 offen offset:1024 lds
    s_waitcnt vmcnt(8)
    ds_read_b64_tr_b16 a[176:177], v23 offset:24576
    ds_read_b64_tr_b16 a[178:179], v23 offset:25600
    ds_read_b64_tr_b16 a[180:181], v24 offset:24576
    ds_read_b64_tr_b16 a[182:183], v24 offset:25600
    s_add_u32 m0, s20, 16384
    s_add_u32 s16, s92, 9
    s_sub_u32 s90, s16, 28
    s_cselect_b32 s16, s16, s90
    s_lshl_b32 s16, s16, 16
    s_add_u32 s16, s16, s33
    buffer_load_dwordx4 v19, s[68:71], s16 offen lds
    buffer_load_dwordx4 v20, s[68:71], s16 offen offset:1024 lds
    s_waitcnt vmcnt(8)
    ds_read_b64_tr_b16 a[88:89], v23 offset:26624
    ds_read_b64_tr_b16 a[90:91], v23 offset:27648
    ds_read_b64_tr_b16 a[92:93], v24 offset:26624
    ds_read_b64_tr_b16 a[94:95], v24 offset:27648
    s_add_u32 m0, s20, 18432
    s_add_u32 s16, s92, 10
    s_sub_u32 s90, s16, 28
    s_cselect_b32 s16, s16, s90
    s_lshl_b32 s16, s16, 16
    s_add_u32 s16, s16, s33
    buffer_load_dwordx4 v19, s[68:71], s16 offen lds
    buffer_load_dwordx4 v20, s[68:71], s16 offen offset:1024 lds
    s_waitcnt vmcnt(8)
    ds_read_b64_tr_b16 a[0:1], v23 offset:4096
    ds_read_b64_tr_b16 a[2:3], v23 offset:5120
    ds_read_b64_tr_b16 a[4:5], v24 offset:4096
    ds_read_b64_tr_b16 a[6:7], v24 offset:5120
    s_add_u32 m0, s20, 20480
    s_add_u32 s16, s92, 11
    s_sub_u32 s90, s16, 28
    s_cselect_b32 s16, s16, s90
    s_lshl_b32 s16, s16, 16
    s_add_u32 s16, s16, s33
    buffer_load_dwordx4 v19, s[68:71], s16 offen lds
    buffer_load_dwordx4 v20, s[68:71], s16 offen offset:1024 lds
    s_waitcnt vmcnt(8)
    ds_read_b64_tr_b16 a[104:105], v23 offset:6144
    ds_read_b64_tr_b16 a[106:107], v23 offset:7168
    ds_read_b64_tr_b16 a[108:109], v24 offset:6144
    ds_read_b64_tr_b16 a[110:111], v24 offset:7168
    s_add_u32 m0, s20, 22528
    s_add_u32 s16, s92, 12
    s_sub_u32 s90, s16, 28
    s_cselect_b32 s16, s16, s90
    s_lshl_b32 s16, s16, 16
    s_add_u32 s16, s16, s33
    buffer_load_dwordx4 v19, s[68:71], s16 offen lds
    buffer_load_dwordx4 v20, s[68:71], s16 offen offset:1024 lds
    s_add_u32 m0, s20, 10240
    s_add_u32 s16, s92, 13
    s_sub_u32 s90, s16, 28
    s_cselect_b32 s16, s16, s90
    s_lshl_b32 s16, s16, 16
    s_add_u32 s16, s16, s33
    buffer_load_dwordx4 v19, s[68:71], s16 offen lds
    buffer_load_dwordx4 v20, s[68:71], s16 offen offset:1024 lds
    s_waitcnt lgkmcnt(15)
    s_add_u32 m0, s20, 12288
    s_add_u32 s16, s92, 14
    s_sub_u32 s90, s16, 28
    s_cselect_b32 s16, s16, s90
    s_lshl_b32 s16, s16, 16
    s_add_u32 s16, s16, s33
    buffer_load_dwordx4 v19, s[68:71], s16 offen lds
    buffer_load_dwordx4 v20, s[68:71], s16 offen offset:1024 lds
    s_add_u32 m0, s20, 14336
    s_add_u32 s16, s92, 15
    s_sub_u32 s90, s16, 28
    s_cselect_b32 s16, s16, s90
    s_lshl_b32 s16, s16, 16
    s_add_u32 s16, s16, s33
    buffer_load_dwordx4 v19, s[68:71], s16 offen lds
    buffer_load_dwordx4 v20, s[68:71], s16 offen offset:1024 lds
    s_add_u32 m0, s20, 0
    s_add_u32 s16, s92, 16
    s_sub_u32 s90, s16, 28
    s_cselect_b32 s16, s16, s90
    s_lshl_b32 s16, s16, 16
    s_add_u32 s16, s16, s33
    buffer_load_dwordx4 v19, s[68:71], s16 offen lds
    buffer_load_dwordx4 v20, s[68:71], s16 offen offset:1024 lds
    s_add_u32 m0, s20, 2048
    s_add_u32 s16, s92, 17
    s_sub_u32 s90, s16, 28
    s_cselect_b32 s16, s16, s90
    s_lshl_b32 s16, s16, 16
    s_add_u32 s16, s16, s33
    buffer_load_dwordx4 v19, s[68:71], s16 offen lds
    buffer_load_dwordx4 v20, s[68:71], s16 offen offset:1024 lds
    s_waitcnt lgkmcnt(12)
    s_add_u32 m0, s20, 24576
    s_add_u32 s16, s92, 18
    s_sub_u32 s90, s16, 28
    s_cselect_b32 s16, s16, s90
    s_lshl_b32 s16, s16, 16
    s_add_u32 s16, s16, s33
    buffer_load_dwordx4 v19, s[68:71], s16 offen lds
    buffer_load_dwordx4 v20, s[68:71], s16 offen offset:1024 lds
    s_waitcnt lgkmcnt(8)
    s_add_u32 m0, s20, 26624
    s_add_u32 s16, s92, 19
    s_sub_u32 s90, s16, 28
    s_cselect_b32 s16, s16, s90
    s_lshl_b32 s16, s16, 16
    s_add_u32 s16, s16, s33
    buffer_load_dwordx4 v19, s[68:71], s16 offen lds
    buffer_load_dwordx4 v20, s[68:71], s16 offen offset:1024 lds
    s_waitcnt lgkmcnt(4)
    s_add_u32 m0, s20, 4096
    s_add_u32 s16, s92, 20
    s_sub_u32 s90, s16, 28
    s_cselect_b32 s16, s16, s90
    s_lshl_b32 s16, s16, 16
    s_add_u32 s16, s16, s33
    buffer_load_dwordx4 v19, s[68:71], s16 offen lds
    buffer_load_dwordx4 v20, s[68:71], s16 offen offset:1024 lds
    s_waitcnt lgkmcnt(0)
    s_add_u32 m0, s20, 6144
    s_add_u32 s16, s92, 21
    s_sub_u32 s90, s16, 28
    s_cselect_b32 s16, s16, s90
    s_lshl_b32 s16, s16, 16
    s_add_u32 s16, s16, s33
    buffer_load_dwordx4 v19, s[68:71], s16 offen lds
    buffer_load_dwordx4 v20, s[68:71], s16 offen offset:1024 lds
    s_waitcnt vmcnt(26)
    ds_read_b64_tr_b16 a[8:9], v23 offset:8192
    ds_read_b64_tr_b16 a[10:11], v23 offset:9216
    ds_read_b64_tr_b16 a[12:13], v24 offset:8192
    ds_read_b64_tr_b16 a[14:15], v24 offset:9216
    s_waitcnt lgkmcnt(0)
    s_add_u32 m0, s20, 8192
    s_add_u32 s16, s92, 22
    s_sub_u32 s90, s16, 28
    s_cselect_b32 s16, s16, s90
    s_lshl_b32 s16, s16, 16
    s_add_u32 s16, s16, s33
    buffer_load_dwordx4 v19, s[68:71], s16 offen lds
    buffer_load_dwordx4 v20, s[68:71], s16 offen offset:1024 lds
    s_waitcnt vmcnt(26)
    ds_read_b64_tr_b16 a[184:185], v23 offset:16384
    ds_read_b64_tr_b16 a[186:187], v23 offset:17408
    ds_read_b64_tr_b16 a[188:189], v24 offset:16384
    ds_read_b64_tr_b16 a[190:191], v24 offset:17408
    s_waitcnt lgkmcnt(0)
    s_add_u32 m0, s20, 16384
    s_add_u32 s16, s92, 23
    s_sub_u32 s90, s16, 28
    s_cselect_b32 s16, s16, s90
    s_lshl_b32 s16, s16, 16
    s_add_u32 s16, s16, s33
    buffer_load_dwordx4 v19, s[68:71], s16 offen lds
    buffer_load_dwordx4 v20, s[68:71], s16 offen offset:1024 lds
    s_waitcnt vmcnt(26)
    ds_read_b64_tr_b16 a[16:17], v23 offset:18432
    ds_read_b64_tr_b16 a[18:19], v23 offset:19456
    ds_read_b64_tr_b16 a[20:21], v24 offset:18432
    ds_read_b64_tr_b16 a[22:23], v24 offset:19456
    s_waitcnt lgkmcnt(0)
    s_add_u32 m0, s20, 18432
    s_add_u32 s16, s92, 24
    s_sub_u32 s90, s16, 28
    s_cselect_b32 s16, s16, s90
    s_lshl_b32 s16, s16, 16
    s_add_u32 s16, s16, s33
    buffer_load_dwordx4 v19, s[68:71], s16 offen lds
    buffer_load_dwordx4 v20, s[68:71], s16 offen offset:1024 lds
    s_waitcnt vmcnt(26)
    ds_read_b64_tr_b16 a[48:49], v23 offset:20480
    ds_read_b64_tr_b16 a[50:51], v23 offset:21504
    ds_read_b64_tr_b16 a[52:53], v24 offset:20480
    ds_read_b64_tr_b16 a[54:55], v24 offset:21504
    s_waitcnt lgkmcnt(0)
    s_add_u32 m0, s20, 20480
    s_add_u32 s16, s92, 25
    s_sub_u32 s90, s16, 28
    s_cselect_b32 s16, s16, s90
    s_lshl_b32 s16, s16, 16
    s_add_u32 s16, s16, s33
    buffer_load_dwordx4 v19, s[68:71], s16 offen lds
    buffer_load_dwordx4 v20, s[68:71], s16 offen offset:1024 lds
    s_branch L_p3
L_ofin:
    s_lshl_b32 s5, s12, 2
    s_add_u32 s5, s5, s10
    s_lshl_b32 s5, s5, 1
    s_lshl_b32 s6, s5, 7
    s_add_u32 s38, s6, 0xc34000
    v_and_b32 v2, 1, v1
    v_and_b32 v3, 2, v1
    v_lshl_add_u32 v2, v3, 1, v2
    v_lshlrev_b32 v9, 7, v2
    buffer_load_dword v8, v9, s[84:87], s38 offen sc1
    s_lshl_b32 s6, s5, 11
    s_add_u32 s7, s6, 0x200000
    s_lshl_b32 s8, s11, 1
    s_add_u32 s8, s8, s9
    s_lshl_b32 s15, s8, 16
    s_add_u32 s15, s15, s6
    s_add_u32 s15, s15, 0x600000
    s_lshl_b32 s5, s12, 1
    s_add_u32 s5, s5, s10
    s_lshl_b32 s5, s5, 5
    s_add_u32 s5, s5, s8
    s_lshl_b32 s5, s5, 7
    s_add_u32 s42, s5, 0xc60000
    s_add_u32 m0, s20, 22528
    s_add_u32 s16, s92, 12
    s_sub_u32 s90, s16, 28
    s_cselect_b32 s16, s16, s90
    s_lshl_b32 s16, s16, 16
    s_add_u32 s16, s16, s33
    buffer_load_dwordx4 v19, s[68:71], s16 offen lds
    buffer_load_dwordx4 v20, s[68:71], s16 offen offset:1024 lds
    s_add_u32 m0, s20, 10240
    s_add_u32 s16, s92, 13
    s_sub_u32 s90, s16, 28
    s_cselect_b32 s16, s16, s90
    s_lshl_b32 s16, s16, 16
    s_add_u32 s16, s16, s33
    buffer_load_dwordx4 v19, s[68:71], s16 offen lds
    buffer_load_dwordx4 v20, s[68:71], s16 offen offset:1024 lds
    s_add_u32 m0, s20, 12288
    s_add_u32 s16, s92, 14
    s_sub_u32 s90, s16, 28
    s_cselect_b32 s16, s16, s90
    s_lshl_b32 s16, s16, 16
    s_add_u32 s16, s16, s33
    buffer_load_dwordx4 v19, s[68:71], s16 offen lds
    buffer_load_dwordx4 v20, s[68:71], s16 offen offset:1024 lds
    s_add_u32 m0, s20, 14336
    s_add_u32 s16, s92, 15
    s_sub_u32 s90, s16, 28
    s_cselect_b32 s16, s16, s90
    s_lshl_b32 s16, s16, 16
    s_add_u32 s16, s16, s33
    buffer_load_dwordx4 v19, s[68:71], s16 offen lds
    buffer_load_dwordx4 v20, s[68:71], s16 offen offset:1024 lds
    s_add_u32 m0, s20, 0
    s_add_u32 s16, s92, 16
    s_sub_u32 s90, s16, 28
    s_cselect_b32 s16, s16, s90
    s_lshl_b32 s16, s16, 16
    s_add_u32 s16, s16, s33
    buffer_load_dwordx4 v19, s[68:71], s16 offen lds
    buffer_load_dwordx4 v20, s[68:71], s16 offen offset:1024 lds
    s_waitcnt vmcnt(10)
    v_cmp_ne_u32 vcc, s4, v8
    s_mov_b32 s19, 0x40000
    s_cmp_lg_u64 vcc, 0
    s_cbranch_scc1 L_spin7
L_go7:
    buffer_load_dwordx4 v[140:143], v6, s[84:87], s7 offen offset:0 sc1
    buffer_load_dwordx4 v[144:147], v6, s[84:87], s7 offen offset:1024 sc1
    buffer_load_dwordx4 v[148:151], v6, s[84:87], s7 offen offset:2048 sc1
    buffer_load_dwordx4 v[152:155], v6, s[84:87], s7 offen offset:3072 sc1
    s_add_u32 s7, s7, 8192
    buffer_load_dwordx4 v[156:159], v6, s[84:87], s7 offen offset:0 sc1
    buffer_load_dwordx4 v[160:163], v6, s[84:87], s7 offen offset:1024 sc1
    buffer_load_dwordx4 v[164:167], v6, s[84:87], s7 offen offset:2048 sc1
    buffer_load_dwordx4 v[168:171], v6, s[84:87], s7 offen offset:3072 sc1
    s_waitcnt lgkmcnt(15)
    s_add_u32 m0, s20, 2048
    s_add_u32 s16, s92, 17
    s_sub_u32 s90, s16, 28
    s_cselect_b32 s16, s16, s90
    s_lshl_b32 s16, s16, 16
    s_add_u32 s16, s16, s33
    buffer_load_dwordx4 v19, s[68:71], s16 offen lds
    buffer_load_dwordx4 v20, s[68:71], s16 offen offset:1024 lds
    s_waitcnt lgkmcnt(12)
    s_add_u32 m0, s20, 24576
    s_add_u32 s16, s92, 18
    s_sub_u32 s90, s16, 28
    s_cselect_b32 s16, s16, s90
    s_lshl_b32 s16, s16, 16
    s_add_u32 s16, s16, s33
    buffer_load_dwordx4 v19, s[68:71], s16 offen lds
    buffer_load_dwordx4 v20, s[68:71], s16 offen offset:1024 lds
    s_waitcnt lgkmcnt(8)
    s_add_u32 m0, s20, 26624
    s_add_u32 s16, s92, 19
    s_sub_u32 s90, s16, 28
    s_cselect_b32 s16, s16, s90
    s_lshl_b32 s16, s16, 16
    s_add_u32 s16, s16, s33
    buffer_load_dwordx4 v19, s[68:71], s16 offen lds
    buffer_load_dwordx4 v20, s[68:71], s16 offen offset:1024 lds
    s_waitcnt lgkmcnt(4)
    s_add_u32 m0, s20, 4096
    s_add_u32 s16, s92, 20
    s_sub_u32 s90, s16, 28
    s_cselect_b32 s16, s16, s90
    s_lshl_b32 s16, s16, 16
    s_add_u32 s16, s16, s33
    buffer_load_dwordx4 v19, s[68:71], s16 offen lds
    buffer_load_dwordx4 v20, s[68:71], s16 offen offset:1024 lds
    s_waitcnt lgkmcnt(0)
    s_add_u32 m0, s20, 6144
    s_add_u32 s16, s92, 21
    s_sub_u32 s90, s16, 28
    s_cselect_b32 s16, s16, s90
    s_lshl_b32 s16, s16, 16
    s_add_u32 s16, s16, s33
    buffer_load_dwordx4 v19, s[68:71], s16 offen lds
    buffer_load_dwordx4 v20, s[68:71], s16 offen offset:1024 lds
    s_waitcnt vmcnt(16)
    v_mfma_f32_32x32x16_bf16 v[44:59], v[140:143], v[188:191], 0
    ds_read_b64_tr_b16 a[8:9], v23 offset:8192
    ds_read_b64_tr_b16 a[10:11], v23 offset:9216
    ds_read_b64_tr_b16 a[12:13], v24 offset:8192
    ds_read_b64_tr_b16 a[14:15], v24 offset:9216
    v_mfma_f32_32x32x16_bf16 v[60:75], v[144:147], v[192:195], 0
    v_mfma_f32_32x32x16_bf16 v[76:91], v[140:143], v[204:207], 0
    s_waitcnt lgkmcnt(0)
    s_add_u32 m0, s20, 8192
    s_add_u32 s16, s92, 22
    s_sub_u32 s90, s16, 28
    s_cselect_b32 s16, s16, s90
    s_lshl_b32 s16, s16, 16
    s_add_u32 s16, s16, s33
    buffer_load_dwordx4 v19, s[68:71], s16 offen lds
    buffer_load_dwordx4 v20, s[68:71], s16 offen offset:1024 lds
    v_mfma_f32_32x32x16_bf16 v[92:107], v[144:147], v[208:211], 0
    ds_read_b64_tr_b16 a[184:185], v23 offset:16384
    ds_read_b64_tr_b16 a[186:187], v23 offset:17408
    ds_read_b64_tr_b16 a[188:189], v24 offset:16384
    ds_read_b64_tr_b16 a[190:191], v24 offset:17408
    s_waitcnt vmcnt(16)
    v_mfma_f32_32x32x16_bf16 v[108:123], v[148:151], v[196:199], 0
    v_mfma_f32_32x32x16_bf16 v[124:139], v[152:155], v[200:203], 0
    s_waitcnt lgkmcnt(0)
    s_add_u32 m0, s20, 16384
    s_add_u32 s16, s92, 23
    s_sub_u32 s90, s16, 28
    s_cselect_b32 s16, s16, s90
    s_lshl_b32 s16, s16, 16
    s_add_u32 s16, s16, s33
    buffer_load_dwordx4 v19, s[68:71], s16 offen lds
    buffer_load_dwordx4 v20, s[68:71], s16 offen offset:1024 lds
    v_rcp_f32 v54, v53
    v_rcp_f32 v70, v69
    v_mov_b32 v28, 0x358637bd
    v_fmac_f32 v28, v52, v54
    v_fmac_f32 v28, v68, v70
    v_rcp_f32 v28, v28
    s_nop 0
    v_mul_f32 v54, v54, v28
    ds_read_b64_tr_b16 a[16:17], v23 offset:18432
    ds_read_b64_tr_b16 a[18:19], v23 offset:19456
    ds_read_b64_tr_b16 a[20:21], v24 offset:18432
    ds_read_b64_tr_b16 a[22:23], v24 offset:19456
    v_mul_f32 v70, v70, v28
    v_pk_mul_f32 v[44:45], v[44:45], v[54:55] op_sel_hi:[1,0]
    v_pk_mul_f32 v[46:47], v[46:47], v[54:55] op_sel_hi:[1,0]
    v_pk_mul_f32 v[48:49], v[48:49], v[54:55] op_sel_hi:[1,0]
    v_pk_mul_f32 v[50:51], v[50:51], v[54:55] op_sel_hi:[1,0]
    v_pk_fma_f32 v[44:45], v[60:61], v[70:71], v[44:45] op_sel_hi:[1,0,1]
    v_pk_fma_f32 v[46:47], v[62:63], v[70:71], v[46:47] op_sel_hi:[1,0,1]
    v_pk_fma_f32 v[48:49], v[64:65], v[70:71], v[48:49] op_sel_hi:[1,0,1]
    v_pk_fma_f32 v[50:51], v[66:67], v[70:71], v[50:51] op_sel_hi:[1,0,1]
    v_cvt_pk_bf16_f32 v188, v44, v45
    v_cvt_pk_bf16_f32 v189, v46, v47
    v_cvt_pk_bf16_f32 v190, v48, v49
    v_cvt_pk_bf16_f32 v191, v50, v51
    s_waitcnt lgkmcnt(0)
    s_add_u32 m0, s20, 18432
    s_add_u32 s16, s92, 24
    s_sub_u32 s90, s16, 28
    s_cselect_b32 s16, s16, s90
    s_lshl_b32 s16, s16, 16
    s_add_u32 s16, s16, s33
    buffer_load_dwordx4 v19, s[68:71], s16 offen lds
    buffer_load_dwordx4 v20, s[68:71], s16 offen offset:1024 lds
    buffer_store_dwordx4 v[188:191], v6, s[84:87], s15 offen offset:0 sc1
    v_mfma_f32_32x32x16_bf16 v[44:59], v[148:151], v[212:215], 0
    ds_read_b64_tr_b16 a[48:49], v23 offset:20480
    ds_read_b64_tr_b16 a[50:51], v23 offset:21504
    ds_read_b64_tr_b16 a[52:53], v24 offset:20480
    ds_read_b64_tr_b16 a[54:55], v24 offset:21504
    v_mfma_f32_32x32x16_bf16 v[60:75], v[152:155], v[216:219], 0
    v_rcp_f32 v86, v85
    v_rcp_f32 v102, v101
    v_mov_b32 v28, 0x358637bd
    v_fmac_f32 v28, v84, v86
    v_fmac_f32 v28, v100, v102
    v_rcp_f32 v28, v28
    s_nop 0
    v_mul_f32 v86, v86, v28
    v_mul_f32 v102, v102, v28
    v_pk_mul_f32 v[76:77], v[76:77], v[86:87] op_sel_hi:[1,0]
    s_waitcnt lgkmcnt(0)
    s_add_u32 m0, s20, 20480
    s_add_u32 s16, s92, 25
    s_sub_u32 s90, s16, 28
    s_cselect_b32 s16, s16, s90
    s_lshl_b32 s16, s16, 16
    s_add_u32 s16, s16, s33
    buffer_load_dwordx4 v19, s[68:71], s16 offen lds
    buffer_load_dwordx4 v20, s[68:71], s16 offen offset:1024 lds
    v_pk_mul_f32 v[78:79], v[78:79], v[86:87] op_sel_hi:[1,0]
    v_pk_mul_f32 v[80:81], v[80:81], v[86:87] op_sel_hi:[1,0]
    v_pk_mul_f32 v[82:83], v[82:83], v[86:87] op_sel_hi:[1,0]
    v_pk_fma_f32 v[76:77], v[92:93], v[102:103], v[76:77] op_sel_hi:[1,0,1]
    v_pk_fma_f32 v[78:79], v[94:95], v[102:103], v[78:79] op_sel_hi:[1,0,1]
    v_pk_fma_f32 v[80:81], v[96:97], v[102:103], v[80:81] op_sel_hi:[1,0,1]
    v_pk_fma_f32 v[82:83], v[98:99], v[102:103], v[82:83] op_sel_hi:[1,0,1]
    v_cvt_pk_bf16_f32 v204, v76, v77
    v_cvt_pk_bf16_f32 v205, v78, v79
    v_cvt_pk_bf16_f32 v206, v80, v81
    v_cvt_pk_bf16_f32 v207, v82, v83
    buffer_store_dwordx4 v[204:207], v6, s[84:87], s15 offen offset:1024 sc1
    s_waitcnt vmcnt(22)
    v_mfma_f32_32x32x16_bf16 v[76:91], v[156:159], v[220:223], 0
    v_mfma_f32_32x32x16_bf16 v[92:107], v[160:163], v[224:227], 0
    v_rcp_f32 v118, v117
    v_rcp_f32 v134, v133
    v_mov_b32 v28, 0x358637bd
    v_fmac_f32 v28, v116, v118
    v_fmac_f32 v28, v132, v134
    v_rcp_f32 v28, v28
    s_nop 0
    v_mul_f32 v118, v118, v28
    v_mul_f32 v134, v134, v28
    v_pk_mul_f32 v[108:109], v[108:109], v[118:119] op_sel_hi:[1,0]
    v_pk_mul_f32 v[110:111], v[110:111], v[118:119] op_sel_hi:[1,0]
    v_pk_mul_f32 v[112:113], v[112:113], v[118:119] op_sel_hi:[1,0]
    v_pk_mul_f32 v[114:115], v[114:115], v[118:119] op_sel_hi:[1,0]
    v_pk_fma_f32 v[108:109], v[124:125], v[134:135], v[108:109] op_sel_hi:[1,0,1]
    v_pk_fma_f32 v[110:111], v[126:127], v[134:135], v[110:111] op_sel_hi:[1,0,1]
    v_pk_fma_f32 v[112:113], v[128:129], v[134:135], v[112:113] op_sel_hi:[1,0,1]
    v_pk_fma_f32 v[114:115], v[130:131], v[134:135], v[114:115] op_sel_hi:[1,0,1]
    v_cvt_pk_bf16_f32 v196, v108, v109
    v_cvt_pk_bf16_f32 v197, v110, v111
    v_cvt_pk_bf16_f32 v198, v112, v113
    v_cvt_pk_bf16_f32 v199, v114, v115
    buffer_store_dwordx4 v[196:199], v6, s[84:87], s15 offen offset:2048 sc1
    v_mfma_f32_32x32x16_bf16 v[108:123], v[156:159], v[236:239], 0
    v_mfma_f32_32x32x16_bf16 v[124:139], v[160:163], v[240:243], 0
    v_rcp_f32 v54, v53
    v_rcp_f32 v70, v69
    v_mov_b32 v28, 0x358637bd
    v_fmac_f32 v28, v52, v54
    v_fmac_f32 v28, v68, v70
    v_rcp_f32 v28, v28
    s_nop 0
    v_mul_f32 v54, v54, v28
    v_mul_f32 v70, v70, v28
    v_pk_mul_f32 v[44:45], v[44:45], v[54:55] op_sel_hi:[1,0]
    v_pk_mul_f32 v[46:47], v[46:47], v[54:55] op_sel_hi:[1,0]
    v_pk_mul_f32 v[48:49], v[48:49], v[54:55] op_sel_hi:[1,0]
    v_pk_mul_f32 v[50:51], v[50:51], v[54:55] op_sel_hi:[1,0]
    v_pk_fma_f32 v[44:45], v[60:61], v[70:71], v[44:45] op_sel_hi:[1,0,1]
    v_pk_fma_f32 v[46:47], v[62:63], v[70:71], v[46:47] op_sel_hi:[1,0,1]
    v_pk_fma_f32 v[48:49], v[64:65], v[70:71], v[48:49] op_sel_hi:[1,0,1]
    v_pk_fma_f32 v[50:51], v[66:67], v[70:71], v[50:51] op_sel_hi:[1,0,1]
    v_cvt_pk_bf16_f32 v212, v44, v45
    v_cvt_pk_bf16_f32 v213, v46, v47
    v_cvt_pk_bf16_f32 v214, v48, v49
    v_cvt_pk_bf16_f32 v215, v50, v51
    buffer_store_dwordx4 v[212:215], v6, s[84:87], s15 offen offset:3072 sc1
    s_waitcnt vmcnt(22)
    v_mfma_f32_32x32x16_bf16 v[44:59], v[164:167], v[228:231], 0
    v_mfma_f32_32x32x16_bf16 v[60:75], v[168:171], v[232:235], 0
    v_rcp_f32 v86, v85
    v_rcp_f32 v102, v101
    v_mov_b32 v28, 0x358637bd
    v_fmac_f32 v28, v84, v86
    v_fmac_f32 v28, v100, v102
    v_rcp_f32 v28, v28
    s_nop 0
    v_mul_f32 v86, v86, v28
    v_mul_f32 v102, v102, v28
    v_pk_mul_f32 v[76:77], v[76:77], v[86:87] op_sel_hi:[1,0]
    v_pk_mul_f32 v[78:79], v[78:79], v[86:87] op_sel_hi:[1,0]
    v_pk_mul_f32 v[80:81], v[80:81], v[86:87] op_sel_hi:[1,0]
    v_pk_mul_f32 v[82:83], v[82:83], v[86:87] op_sel_hi:[1,0]
    v_pk_fma_f32 v[76:77], v[92:93], v[102:103], v[76:77] op_sel_hi:[1,0,1]
    v_pk_fma_f32 v[78:79], v[94:95], v[102:103], v[78:79] op_sel_hi:[1,0,1]
    v_pk_fma_f32 v[80:81], v[96:97], v[102:103], v[80:81] op_sel_hi:[1,0,1]
    v_pk_fma_f32 v[82:83], v[98:99], v[102:103], v[82:83] op_sel_hi:[1,0,1]
    v_cvt_pk_bf16_f32 v220, v76, v77
    v_cvt_pk_bf16_f32 v221, v78, v79
    v_cvt_pk_bf16_f32 v222, v80, v81
    v_cvt_pk_bf16_f32 v223, v82, v83
    s_add_u32 s15, s15, 8192
    buffer_store_dwordx4 v[220:223], v6, s[84:87], s15 offen offset:0 sc1
    v_mfma_f32_32x32x16_bf16 v[76:91], v[164:167], v[244:247], 0
    v_mfma_f32_32x32x16_bf16 v[92:107], v[168:171], v[248:251], 0
    v_rcp_f32 v118, v117
    v_rcp_f32 v134, v133
    v_mov_b32 v28, 0x358637bd
    v_fmac_f32 v28, v116, v118
    v_fmac_f32 v28, v132, v134
    v_rcp_f32 v28, v28
    s_nop 0
    v_mul_f32 v118, v118, v28
    v_mul_f32 v134, v134, v28
    v_pk_mul_f32 v[108:109], v[108:109], v[118:119] op_sel_hi:[1,0]
    v_pk_mul_f32 v[110:111], v[110:111], v[118:119] op_sel_hi:[1,0]
    v_pk_mul_f32 v[112:113], v[112:113], v[118:119] op_sel_hi:[1,0]
    v_pk_mul_f32 v[114:115], v[114:115], v[118:119] op_sel_hi:[1,0]
    v_pk_fma_f32 v[108:109], v[124:125], v[134:135], v[108:109] op_sel_hi:[1,0,1]
    v_pk_fma_f32 v[110:111], v[126:127], v[134:135], v[110:111] op_sel_hi:[1,0,1]
    v_pk_fma_f32 v[112:113], v[128:129], v[134:135], v[112:113] op_sel_hi:[1,0,1]
    v_pk_fma_f32 v[114:115], v[130:131], v[134:135], v[114:115] op_sel_hi:[1,0,1]
    v_cvt_pk_bf16_f32 v236, v108, v109
    v_cvt_pk_bf16_f32 v237, v110, v111
    v_cvt_pk_bf16_f32 v238, v112, v113
    v_cvt_pk_bf16_f32 v239, v114, v115
    buffer_store_dwordx4 v[236:239], v6, s[84:87], s15 offen offset:1024 sc1
    v_rcp_f32 v54, v53
    v_rcp_f32 v70, v69
    v_mov_b32 v28, 0x358637bd
    v_fmac_f32 v28, v52, v54
    v_fmac_f32 v28, v68, v70
    v_rcp_f32 v28, v28
    s_nop 0
    v_mul_f32 v54, v54, v28
    v_mul_f32 v70, v70, v28
    v_pk_mul_f32 v[44:45], v[44:45], v[54:55] op_sel_hi:[1,0]
    v_pk_mul_f32 v[46:47], v[46:47], v[54:55] op_sel_hi:[1,0]
    v_pk_mul_f32 v[48:49], v[48:49], v[54:55] op_sel_hi:[1,0]
    v_pk_mul_f32 v[50:51], v[50:51], v[54:55] op_sel_hi:[1,0]
    v_pk_fma_f32 v[44:45], v[60:61], v[70:71], v[44:45] op_sel_hi:[1,0,1]
    v_pk_fma_f32 v[46:47], v[62:63], v[70:71], v[46:47] op_sel_hi:[1,0,1]
    v_pk_fma_f32 v[48:49], v[64:65], v[70:71], v[48:49] op_sel_hi:[1,0,1]
    v_pk_fma_f32 v[50:51], v[66:67], v[70:71], v[50:51] op_sel_hi:[1,0,1]
    v_cvt_pk_bf16_f32 v228, v44, v45
    v_cvt_pk_bf16_f32 v229, v46, v47
    v_cvt_pk_bf16_f32 v230, v48, v49
    v_cvt_pk_bf16_f32 v231, v50, v51
    buffer_store_dwordx4 v[228:231], v6, s[84:87], s15 offen offset:2048 sc1
    v_rcp_f32 v86, v85
    v_rcp_f32 v102, v101
    v_mov_b32 v28, 0x358637bd
    v_fmac_f32 v28, v84, v86
    v_fmac_f32 v28, v100, v102
    v_rcp_f32 v28, v28
    s_nop 0
    v_mul_f32 v86, v86, v28
    v_mul_f32 v102, v102, v28
    v_pk_mul_f32 v[76:77], v[76:77], v[86:87] op_sel_hi:[1,0]
    v_pk_mul_f32 v[78:79], v[78:79], v[86:87] op_sel_hi:[1,0]
    v_pk_mul_f32 v[80:81], v[80:81], v[86:87] op_sel_hi:[1,0]
    v_pk_mul_f32 v[82:83], v[82:83], v[86:87] op_sel_hi:[1,0]
    v_pk_fma_f32 v[76:77], v[92:93], v[102:103], v[76:77] op_sel_hi:[1,0,1]
    v_pk_fma_f32 v[78:79], v[94:95], v[102:103], v[78:79] op_sel_hi:[1,0,1]
    v_pk_fma_f32 v[80:81], v[96:97], v[102:103], v[80:81] op_sel_hi:[1,0,1]
    v_pk_fma_f32 v[82:83], v[98:99], v[102:103], v[82:83] op_sel_hi:[1,0,1]
    v_cvt_pk_bf16_f32 v244, v76, v77
    v_cvt_pk_bf16_f32 v245, v78, v79
    v_cvt_pk_bf16_f32 v246, v80, v81
    v_cvt_pk_bf16_f32 v247, v82, v83
    buffer_store_dwordx4 v[244:247], v6, s[84:87], s15 offen offset:3072 sc1
    s_waitcnt vmcnt(0)
    v_mov_b32 v2, s4
    s_mov_b32 exec_hi, 0
    buffer_store_dword v2, v42, s[84:87], s42 offen sc1
    s_mov_b64 exec, -1
    s_branch L_p3
L_spin1:
    buffer_load_dword v8, v9, s[84:87], s38 offen sc1
    s_waitcnt vmcnt(0)
    v_cmp_ne_u32 vcc, s4, v8
    s_sub_u32 s19, s19, 1
    s_cbranch_scc1 L_go1
    s_cmp_eq_u64 vcc, 0
    s_cbranch_scc1 L_go1
    s_sleep 2
    s_branch L_spin1
L_spin2:
    buffer_load_dword v8, v9, s[84:87], s38 offen sc1
    s_waitcnt vmcnt(0)
    v_cmp_ne_u32 vcc, s4, v8
    s_sub_u32 s19, s19, 1
    s_cbranch_scc1 L_go2
    s_cmp_eq_u64 vcc, 0
    s_cbranch_scc1 L_go2
    s_sleep 2
    s_branch L_spin2
L_spin3:
    buffer_load_dword v8, v9, s[84:87], s31 offen sc1
    s_waitcnt vmcnt(0)
    v_cmp_ne_u32 vcc, s4, v8
    s_sub_u32 s19, s19, 1
    s_cbranch_scc1 L_go3
    s_cmp_eq_u64 vcc, 0
    s_cbranch_scc1 L_go3
    s_sleep 2
    s_branch L_spin3
L_spin4:
    buffer_load_dword v8, v5, s[84:87], s30 offen sc1
    s_waitcnt vmcnt(0)
    v_cmp_ne_u32 vcc, s4, v8
    s_sub_u32 s19, s19, 1
    s_cbranch_scc1 L_go4
    s_cmp_eq_u64 vcc, 0
    s_cbranch_scc1 L_go4
    s_sleep 2
    s_branch L_spin4
L_spin5:
    buffer_load_dword v8, v9, s[84:87], s24 offen sc1
    s_waitcnt vmcnt(0)
    v_cmp_ne_u32 vcc, s4, v8
    s_sub_u32 s19, s19, 1
    s_cbranch_scc1 L_go5
    s_cmp_eq_u64 vcc, 0
    s_cbranch_scc1 L_go5
    s_sleep 2
    s_branch L_spin5
L_spin6:
    buffer_load_dword v8, v9, s[84:87], s23 offen sc1
    s_waitcnt vmcnt(0)
    v_cmp_ne_u32 vcc, s4, v8
    s_sub_u32 s19, s19, 1
    s_cbranch_scc1 L_go6
    s_cmp_eq_u64 vcc, 0
    s_cbranch_scc1 L_go6
    s_sleep 2
    s_branch L_spin6
L_spin7:
    buffer_load_dword v8, v9, s[84:87], s38 offen sc1
    s_waitcnt vmcnt(0)
    v_cmp_ne_u32 vcc, s4, v8
    s_sub_u32 s19, s19, 1
    s_cbranch_scc1 L_go7
    s_cmp_eq_u64 vcc, 0
    s_cbranch_scc1 L_go7
    s_sleep 2
    s_branch L_spin7
L_codeend:
    s_endpgm
.section .rodata,"a"
.p2align 6
.amdhsa_kernel gated_mix__linear_kernel_hedgehog__mixer_token_mlp__prompt_kernel
  .amdhsa_next_free_vgpr 512
  .amdhsa_next_free_sgpr 102
  .amdhsa_accum_offset 256
  .amdhsa_group_segment_fixed_size 0
  .amdhsa_kernarg_size 104
  .amdhsa_user_sgpr_count 2
  .amdhsa_user_sgpr_kernarg_segment_ptr 1
  .amdhsa_system_sgpr_workgroup_id_x 1
  .amdhsa_float_denorm_mode_32 3
.end_amdhsa_kernel
```
